```python
import torch

def _softmax(x, axis=-1):
    return torch.softmax(x, dim=axis)
def _gelu(x):
    return torch.nn.functional.gelu(x, approximate="tanh")
def _silu(x):
    return torch.nn.functional.silu(x)
def _sigmoid(x):
    return torch.sigmoid(x)
def _layernorm(x, axis=-1, eps=1e-5):
    m = x.mean(dim=axis, keepdim=True)
    v = x.var(dim=axis, keepdim=True, unbiased=False)
    return (x - m) / torch.sqrt(v + eps)
def _scatter_add(tgt, idx, src, axis=0):
    return tgt.clone().index_add_(axis, idx, src)
def _segment_sum(src, seg, n):
    out = torch.zeros((n,) + src.shape[1:], dtype=src.dtype)
    return out.index_add_(0, seg, src)
def _pad(x, pw):
    flat = tuple(v for pair in reversed(pw) for v in pair)
    return torch.nn.functional.pad(x, flat)

kernel_name = 'parallel_sum__ssm_conv_s4__dense_activation_squared_relu__prompt'

def setup_inputs():

    _w = (lambda a: (lambda t: t.to(torch.bfloat16) if t.is_floating_point() else t)(torch.as_tensor(a)))
    def _A_setup():
        B, L, D, N = 1, 2048, 512, 128
        A_re = -(lambda _x: torch.exp(torch.as_tensor(_x)))((lambda *s: torch.randn(*s, dtype=torch.bfloat16) * 3.2)(D, N))
        A_im = torch.pi * (lambda *s: torch.randn(*s, dtype=torch.bfloat16) * 0.2)(D, N)
        B_re = (lambda *s: torch.randn(*s, dtype=torch.bfloat16) * 0.4)(D, N)
        B_im = (lambda *s: torch.randn(*s, dtype=torch.bfloat16) * 0.4)(D, N)
        C_re = (lambda *s: torch.randn(*s, dtype=torch.bfloat16) * 0.4)(D, N)
        C_im = (lambda *s: torch.randn(*s, dtype=torch.bfloat16) * 0.4)(D, N)
        log_dt = (lambda *s: torch.randn(*s, dtype=torch.bfloat16) * 0.2)(D) * 0.5 - 4.0
        Dskip = (lambda *s: torch.randn(*s, dtype=torch.bfloat16) * 0.4)(D)
        return {
            "u": _w((lambda *s: torch.randn(*s, dtype=torch.bfloat16) * 0.05)(B, L, D)),
            "A_re": _w(A_re),
            "A_im": _w(A_im),
            "B_re": _w(B_re),
            "B_im": _w(B_im),
            "C_re": _w(C_re),
            "C_im": _w(C_im),
            "log_dt": _w(log_dt),
            "Dskip": _w(Dskip),
        }
    _A_in = _A_setup()

    def _B_setup():
        B, S, D, F = 1, 2048, 512, 1792
        return {
            "x": _w((lambda *s: torch.randn(*s, dtype=torch.bfloat16) * 0.05)(B, S, D)),
            "w1": _w((lambda *s: torch.randn(*s, dtype=torch.bfloat16) * 0.05)(D, F)),
            "b1": _w((lambda *s: torch.randn(*s, dtype=torch.bfloat16) * 0.2)(F)),
            "w2": _w((lambda *s: torch.randn(*s, dtype=torch.bfloat16) * 0.05)(F, D)),
            "b2": _w((lambda *s: torch.randn(*s, dtype=torch.bfloat16) * 0.8)(D)),
        }
    _B_in = _B_setup()

    return {
        "A_u": _A_in["u"],
        "A_A_re": _A_in["A_re"],
        "A_A_im": _A_in["A_im"],
        "A_B_re": _A_in["B_re"],
        "A_B_im": _A_in["B_im"],
        "A_C_re": _A_in["C_re"],
        "A_C_im": _A_in["C_im"],
        "A_log_dt": _A_in["log_dt"],
        "A_Dskip": _A_in["Dskip"],
        "B_x": _B_in["x"],
        "B_w1": _B_in["w1"],
        "B_b1": _B_in["b1"],
        "B_w2": _B_in["w2"],
        "B_b2": _B_in["b2"],
    }

def reference(A_u, A_A_re, A_A_im, A_B_re, A_B_im, A_C_re, A_C_im, A_log_dt, A_Dskip, B_x, B_w1, B_b1, B_w2, B_b2):
    def _A_ref(u, A_re, A_im, B_re, B_im, C_re, C_im, log_dt, Dskip):
        Bsz, L, D = u.shape
        dt = torch.exp(log_dt)[:, None]
        A = A_re + 1j * A_im
        Bc = B_re + 1j * B_im
        Cc = C_re + 1j * C_im
        logdA = dt * A
        dB = dt * Bc
        l = (lambda x, dt: x.to(dt))(torch.arange(L), A_re.dtype)
        P = torch.exp(logdA[:, :, None] * l[None, None, :])
        K = torch.einsum("dn,dnl,dn->dl", Cc, P, dB).real
        L2 = 2 * L
        Kp = _pad(K, ((0, 0), (0, L)))
        up = (lambda x, *d: x.permute(*d))(u, 0, 2, 1)
        up = _pad(up, ((0, 0), (0, 0), (0, L)))
        Kf = (lambda x, axes=(-2,-1): torch.fft.rfft2(x.float(), dim=axes))(Kp[:, None, :], axes=(-2, -1))
        Uf = (lambda x, axes=(-2,-1): torch.fft.rfft2(x.float(), dim=axes))(up[:, :, None, :], axes=(-2, -1))
        Yf = Uf * Kf[None, :, :, :]
        y = (lambda x, s, axes=(-2,-1): torch.fft.irfft2(x, s=s, dim=axes).to(torch.bfloat16))(Yf, (1, L2), axes=(-2, -1))[:, :, 0, :L]
        y = (lambda x, *d: x.permute(*d))(y, 0, 2, 1) + u * Dskip[None, None, :]
        return y

    def _B_ref(x, w1, b1, w2, b2):
        h = torch.einsum("bsd,df->bsf", x, w1) + b1
        zero = torch.zeros_like(h)
        r = torch.where(h > zero, h, zero)
        h = r * r
        out = torch.einsum("bsf,fd->bsd", h, w2) + b2
        return out

    x = A_u
    xn = _layernorm(x, axis=-1)
    return x + _A_ref(xn, A_A_re, A_A_im, A_B_re, A_B_im, A_C_re, A_C_im, A_log_dt, A_Dskip) + _B_ref(xn, B_w1, B_b1, B_w2, B_b2)
```

```asm
; @launch grid=(256,1,1) block=(256,1,1) lds=163840
.amdgcn_target "amdgcn-amd-amdhsa--gfx950"
.text
.globl parallel_sum__ssm_conv_s4__dense_activation_squared_relu__prompt_kernel
.p2align 8
.type parallel_sum__ssm_conv_s4__dense_activation_squared_relu__prompt_kernel,@function
parallel_sum__ssm_conv_s4__dense_activation_squared_relu__prompt_kernel:
    s_cmp_ge_u32 s2, 256
    s_cbranch_scc1 L_end
    s_load_dwordx16 s[4:19], s[0:1], 0
    s_load_dwordx16 s[20:35], s[0:1], 64
    s_load_dwordx2 s[36:37], s[0:1], 128
    s_getpc_b64 s[38:39]
    v_lshlrev_b32 v4, 7, v0
    v_min_u32 v4, 24476, v4
    v_mov_b32 v5, s39
    v_add_co_u32 v4, vcc, s38, v4
    s_and_b32 s62, s2, 7
    s_lshr_b32 s63, s2, 3
    v_addc_co_u32 v5, vcc, 0, v5, vcc
    global_load_dword v15, v[4:5], off
    v_lshlrev_b32 v8, 4, v0
    s_lshl_b32 s90, s2, 12
    v_add_u32 v254, s90, v8
    v_add_u32 v255, 917504, v254
    s_cmp_ge_u32 s63, 28
    s_cbranch_scc1 L_nopf
    s_waitcnt lgkmcnt(0)
    global_load_dwordx4 v[248:251], v254, s[24:25] offset:0
L_nopf:
    v_lshrrev_b32 v2, 6, v0
    v_and_b32 v1, 63, v0
    v_readfirstlane_b32 s61, v2
    v_mov_b32 v160, 0
    v_mov_b32 v161, 0
    v_mov_b32 v162, 0
    v_mov_b32 v163, 0
    v_mov_b32 v164, 0
    v_mov_b32 v165, 0
    v_mov_b32 v166, 0
    s_lshr_b32 s74, s63, 3
    s_lshl_b32 s66, s62, 2
    s_add_u32 s66, s66, s74
    s_and_b32 s67, s63, 7
    s_and_b32 s84, s61, 1
    s_lshr_b32 s85, s61, 1
    s_mov_b32 s78, 0xffff0000
    s_lshl_b32 s74, s2, 9
    v_lshlrev_b32 v2, 1, v0
    v_add_u32 v2, s74, v2
    s_lshl_b32 s74, s2, 2
    s_lshl_b32 s75, s85, 1
    s_add_u32 s74, s74, s75
    v_mov_b32 v3, s74
    v_lshrrev_b32 v4, 3, v1
    v_and_b32 v5, 7, v1
    v_lshrrev_b32 v6, 4, v1
    v_and_b32 v7, 1, v6
    v_lshlrev_b32 v7, 2, v7
    v_xor_b32 v7, v7, v5
    v_lshlrev_b32 v7, 4, v7
    v_lshl_add_u32 v24, v4, 10, v7
    v_add_u32 v25, 7168, v24
    v_add_u32 v26, 14336, v24
    v_add_u32 v27, 21504, v24
    s_mul_i32 s70, s61, 458752
    s_lshl_b32 s74, s67, 7
    s_add_u32 s70, s70, s74
    s_lshl_b32 s73, s61, 13
    s_mov_b32 s42, 2097152
    s_mov_b32 s43, 0x20000
    s_mov_b32 s46, 1835008
    s_mov_b32 s47, 0x20000
    s_mov_b32 s50, 1835008
    s_mov_b32 s51, 0x20000
    s_mov_b32 s54, 16777216
    s_mov_b32 s55, 0x20000
    s_mov_b32 s58, 2097152
    s_mov_b32 s59, 0x20000
    s_cmp_ge_u32 s63, 28
    s_cbranch_scc1 L_ln
    s_cmp_ge_u32 s63, 14
    s_cselect_b32 s74, 1, 0
    s_cselect_b32 s75, 14, 0
    s_sub_u32 s65, s63, s75
    s_lshl_b32 s64, s62, 1
    s_add_u32 s64, s64, s74
    v_xor_b32 v7, v5, v6
    v_lshlrev_b32 v7, 4, v7
    v_lshl_add_u32 v16, v4, 10, v7
    v_xor_b32 v17, 64, v16
    v_add_u32 v18, 14336, v16
    v_add_u32 v19, 21504, v17
    v_add_u32 v17, 7168, v17
    v_and_b32 v7, 15, v1
    v_lshlrev_b32 v20, 2, v6
    v_xor_b32 v7, v7, v20
    v_lshlrev_b32 v7, 4, v7
    v_mul_u32_u24 v20, 3584, v6
    v_add_u32 v20, v20, v7
    v_add_u32 v21, 13312, v20
    v_add_u32 v22, 26624, v20
    v_add_u32 v23, 39936, v20
    s_lshl_b32 s68, s64, 17
    s_lshl_b32 s74, s61, 15
    s_add_u32 s68, s68, s74
    s_mul_i32 s69, s61, 57344
    s_lshl_b32 s74, s65, 8
    s_add_u32 s69, s69, s74
    s_lshl_b32 s71, s61, 12
    s_add_u32 s72, s71, 16384
    s_lshl_b32 s75, s61, 6
    s_add_u32 s74, s74, s75
    v_and_b32 v45, 31, v1
    v_lshlrev_b32 v45, 1, v45
    v_add_u32 v45, s74, v45
    v_mov_b32 v171, 0
    s_waitcnt lgkmcnt(0)
    s_mov_b64 s[40:41], s[4:5]
    s_mov_b64 s[44:45], s[24:25]
    global_load_short_d16_hi v160, v2, s[6:7]
    global_load_short_d16_hi v161, v2, s[8:9]
    global_load_short_d16_hi v162, v2, s[10:11]
    global_load_short_d16_hi v163, v2, s[12:13]
    global_load_short_d16_hi v164, v2, s[14:15]
    global_load_short_d16_hi v165, v2, s[16:17]
    global_load_short_d16_hi v166, v3, s[18:19]
    s_load_dword s60, s[36:37], 0
    s_lshl_b32 s74, s67, 7
    s_lshl_b32 s75, s85, 6
    s_add_u32 s74, s74, s75
    s_load_dword s22, s[20:21], s74
    s_load_dword s23, s[30:31], s74
    s_add_u32 m0, s71, 0
    s_add_u32 s86, s68, 0
    buffer_load_dwordx4 v16, s[40:43], s86 offen offset:0 lds
    buffer_load_dwordx4 v17, s[40:43], s86 offen offset:1024 lds
    buffer_load_dwordx4 v18, s[40:43], s86 offen offset:2048 lds
    buffer_load_dwordx4 v19, s[40:43], s86 offen offset:3072 lds
    s_add_u32 m0, s72, 0
    s_add_u32 s86, s69, 0
    buffer_load_dwordx4 v20, s[44:47], s86 offen offset:0 lds
    buffer_load_dwordx4 v21, s[44:47], s86 offen offset:1024 lds
    buffer_load_dwordx4 v22, s[44:47], s86 offen offset:2048 lds
    buffer_load_dwordx4 v23, s[44:47], s86 offen offset:3072 lds
    global_load_dwordx4 v[248:251], v255, s[24:25] offset:0
    s_mov_b64 s[48:49], s[28:29]
    s_mov_b64 s[52:53], s[36:37]
    s_mov_b64 s[56:57], s[32:33]
    s_mov_b32 exec_hi, 0
    global_load_short_d16_hi v171, v45, s[26:27]
    s_mov_b64 exec, -1
    v_and_b32 v2, 31, v1
    v_lshrrev_b32 v3, 5, v1
    v_bfe_u32 v4, v1, 1, 3
    v_xor_b32 v4, v4, v3
    v_lshlrev_b32 v4, 4, v4
    v_lshl_add_u32 v4, v2, 7, v4
    s_add_u32 m0, s71, 32768
    s_add_u32 s86, s68, 128
    buffer_load_dwordx4 v16, s[40:43], s86 offen offset:0 lds
    s_lshl_b32 s74, s84, 13
    v_add_u32 v28, s74, v4
    v_xor_b32 v29, 32, v28
    v_xor_b32 v30, 64, v28
    v_xor_b32 v31, 96, v28
    v_bfe_u32 v4, v1, 2, 2
    v_lshl_add_u32 v2, v3, 3, v4
    v_lshlrev_b32 v2, 8, v2
    v_xor_b32 v4, s61, v4
    v_lshl_add_u32 v2, v4, 6, v2
    buffer_load_dwordx4 v17, s[40:43], s86 offen offset:1024 lds
    v_bfe_u32 v4, v1, 4, 1
    v_lshl_add_u32 v2, v4, 5, v2
    v_and_b32 v3, 3, v1
    v_lshl_add_u32 v2, v3, 3, v2
    v_add_u32 v32, 16384, v2
    v_xor_b32 v33, 64, v32
    v_add_u32 v34, 0x10000, v28
    v_add_u32 v35, 0x10000, v29
    buffer_load_dwordx4 v18, s[40:43], s86 offen offset:2048 lds
    v_add_u32 v36, 0x10000, v30
    v_add_u32 v37, 0x10000, v31
    v_add_u32 v38, 0x10000, v32
    v_add_u32 v39, 0x10000, v33
    v_and_b32 v3, 15, v1
    v_lshlrev_b32 v4, 2, v4
    v_cmp_eq_u32 vcc, v3, v4
    v_mov_b32 v2, 0x3f803f80
    s_nop 0
    v_cndmask_b32 v44, 0, v2, vcc
    v_mov_b32 v45, v44
    v_mov_b32 v46, v44
    v_mov_b32 v47, v44
    buffer_load_dwordx4 v19, s[40:43], s86 offen offset:3072 lds
    s_waitcnt vmcnt(14)
    s_waitcnt lgkmcnt(0)
    s_add_u32 s60, s60, 0x9e3779b9
    s_mov_b32 s17, 0x3fb8aa3b
    v_mul_f32 v167, s17, v166
    v_fma_f32 v168, s17, v166, -v167
    v_fmac_f32 v168, 0x32a57060, v166
    v_exp_f32 v167, v167
    v_mul_f32 v168, 0x3f317218, v168
    v_fma_f32 v167, v167, v168, v167
    v_cvt_pk_bf16_f32 v167, v167, v167
    v_and_b32 v166, s78, v167
    s_add_u32 m0, s72, 32768
    s_add_u32 s86, s69, 229376
    buffer_load_dwordx4 v20, s[44:47], s86 offen offset:0 lds
    v_mul_f32 v160, v166, v160
    v_mul_f32 v161, v166, v161
    v_mul_f32 v162, v166, v162
    v_mul_f32 v163, v166, v163
    v_mul_f32 v160, s17, v160
    v_mul_f32 v161, 0.15915494, v161
    v_mul_f32 v167, 0x41000000, v160
    v_mul_f32 v168, 0x41000000, v161
    v_exp_f32 v167, v167
    v_fract_f32 v168, v168
    buffer_load_dwordx4 v21, s[44:47], s86 offen offset:1024 lds
    v_cos_f32 v169, v168
    v_sin_f32 v170, v168
    v_mul_f32 v178, v167, v169
    v_mul_f32 v179, v167, v170
    v_mul_f32 v167, 0x43000000, v160
    v_mul_f32 v168, 0x43000000, v161
    v_exp_f32 v167, v167
    v_fract_f32 v168, v168
    v_cos_f32 v169, v168
    v_sin_f32 v170, v168
    buffer_load_dwordx4 v22, s[44:47], s86 offen offset:2048 lds
    v_mul_f32 v190, v167, v169
    v_mul_f32 v191, v167, v170
    v_mov_b32 v48, 0x3f80
    v_cvt_pk_bf16_f32 v232, v190, v191
    s_waitcnt vmcnt(9)
    s_barrier
    ds_read_b128 v[136:139], v28 offset:0
    ds_read_b64_tr_b16 v[128:129], v32 offset:0
    ds_read_b64_tr_b16 v[130:131], v32 offset:1024
    ds_read_b128 v[140:143], v28 offset:4096
    ds_read_b64_tr_b16 v[132:133], v33 offset:0
    ds_read_b64_tr_b16 v[134:135], v33 offset:1024
    s_waitcnt lgkmcnt(0)
    v_mfma_f32_32x32x16_bf16 v[64:79], v[128:131], v[136:139], 0
    ds_read_b128 v[152:155], v29 offset:0
    ds_read_b64_tr_b16 v[144:145], v32 offset:4096
    ds_read_b64_tr_b16 v[146:147], v32 offset:5120
    v_mul_f32 v188, v190, v178
    v_mul_f32 v189, v190, v179
    v_fma_f32 v188, -v191, v179, v188
    v_fmac_f32 v189, v191, v178
    v_mfma_f32_32x32x16_bf16 v[80:95], v[128:131], v[140:143], 0
    ds_read_b128 v[156:159], v29 offset:4096
    ds_read_b64_tr_b16 v[148:149], v33 offset:4096
    ds_read_b64_tr_b16 v[150:151], v33 offset:5120
    buffer_load_dwordx4 v23, s[44:47], s86 offen offset:3072 lds
    v_mfma_f32_32x32x16_bf16 v[96:111], v[132:135], v[136:139], 0
    s_add_u32 m0, s71, 65536
    s_add_u32 s86, s68, 256
    buffer_load_dwordx4 v16, s[40:43], s86 offen offset:0 lds
    v_cvt_pk_bf16_f32 v49, v178, v179
    v_cvt_pk_bf16_f32 v233, v188, v189
    v_mul_f32 v184, v178, v178
    v_mul_f32 v185, v178, v179
    v_mfma_f32_32x32x16_bf16 v[112:127], v[132:135], v[140:143], 0
    buffer_load_dwordx4 v17, s[40:43], s86 offen offset:1024 lds
    v_fma_f32 v184, -v179, v179, v184
    v_fmac_f32 v185, v179, v178
    v_mul_f32 v190, v188, v178
    v_mul_f32 v191, v188, v179
    v_fma_f32 v190, -v189, v179, v190
    v_mfma_f32_16x16x32_bf16 v[40:43], v[44:47], v[128:131], 0
    v_fmac_f32 v191, v189, v178
    v_cvt_pk_bf16_f32 v50, v184, v185
    s_waitcnt lgkmcnt(0)
    v_mfma_f32_32x32x16_bf16 v[64:79], v[144:147], v[152:155], v[64:79]
    ds_read_b128 v[136:139], v30 offset:0
    ds_read_b64_tr_b16 v[128:129], v32 offset:8192
    ds_read_b64_tr_b16 v[130:131], v32 offset:9216
    v_cvt_pk_bf16_f32 v234, v190, v191
    v_mul_f32 v186, v184, v178
    v_mul_f32 v187, v184, v179
    v_fma_f32 v186, -v185, v179, v186
    v_mfma_f32_32x32x16_bf16 v[80:95], v[144:147], v[156:159], v[80:95]
    ds_read_b128 v[140:143], v30 offset:4096
    ds_read_b64_tr_b16 v[132:133], v33 offset:8192
    ds_read_b64_tr_b16 v[134:135], v33 offset:9216
    buffer_load_dwordx4 v18, s[40:43], s86 offen offset:2048 lds
    v_mfma_f32_32x32x16_bf16 v[96:111], v[148:151], v[152:155], v[96:111]
    buffer_load_dwordx4 v19, s[40:43], s86 offen offset:3072 lds
    v_fmac_f32 v187, v185, v178
    v_mul_f32 v188, v190, v178
    v_mul_f32 v189, v190, v179
    v_fma_f32 v188, -v191, v179, v188
    v_fmac_f32 v189, v191, v178
    v_mfma_f32_32x32x16_bf16 v[112:127], v[148:151], v[156:159], v[112:127]
    s_add_u32 m0, s72, 65536
    s_add_u32 s86, s69, 458752
    buffer_load_dwordx4 v20, s[44:47], s86 offen offset:0 lds
    v_cvt_pk_bf16_f32 v51, v186, v187
    v_cvt_pk_bf16_f32 v235, v188, v189
    v_mul_f32 v184, v186, v178
    v_mul_f32 v185, v186, v179
    v_mfma_f32_16x16x32_bf16 v[40:43], v[44:47], v[144:147], v[40:43]
    v_fma_f32 v184, -v187, v179, v184
    v_fmac_f32 v185, v187, v178
    s_waitcnt lgkmcnt(0)
    v_mfma_f32_32x32x16_bf16 v[64:79], v[128:131], v[136:139], v[64:79]
    ds_read_b128 v[152:155], v31 offset:0
    ds_read_b64_tr_b16 v[144:145], v32 offset:12288
    ds_read_b64_tr_b16 v[146:147], v32 offset:13312
    v_mul_f32 v190, v188, v178
    v_mul_f32 v191, v188, v179
    v_fma_f32 v190, -v189, v179, v190
    v_fmac_f32 v191, v189, v178
    v_mfma_f32_32x32x16_bf16 v[80:95], v[128:131], v[140:143], v[80:95]
    ds_read_b128 v[156:159], v31 offset:4096
    ds_read_b64_tr_b16 v[148:149], v33 offset:12288
    ds_read_b64_tr_b16 v[150:151], v33 offset:13312
    buffer_load_dwordx4 v21, s[44:47], s86 offen offset:1024 lds
    v_mfma_f32_32x32x16_bf16 v[96:111], v[132:135], v[136:139], v[96:111]
    buffer_load_dwordx4 v22, s[44:47], s86 offen offset:2048 lds
    v_cvt_pk_bf16_f32 v52, v184, v185
    v_cvt_pk_bf16_f32 v236, v190, v191
    v_mul_f32 v186, v184, v178
    v_mul_f32 v187, v184, v179
    v_mfma_f32_32x32x16_bf16 v[112:127], v[132:135], v[140:143], v[112:127]
    buffer_load_dwordx4 v23, s[44:47], s86 offen offset:3072 lds
    v_fma_f32 v186, -v185, v179, v186
    v_fmac_f32 v187, v185, v178
    v_mul_f32 v188, v190, v178
    v_mul_f32 v189, v190, v179
    v_fma_f32 v188, -v191, v179, v188
    v_mfma_f32_16x16x32_bf16 v[40:43], v[44:47], v[128:131], v[40:43]
    v_fmac_f32 v189, v191, v178
    v_cvt_pk_bf16_f32 v53, v186, v187
    s_waitcnt vmcnt(8) lgkmcnt(0)
    s_barrier
    v_mfma_f32_32x32x16_bf16 v[64:79], v[144:147], v[152:155], v[64:79]
    ds_read_b128 v[136:139], v28 offset:32768
    ds_read_b64_tr_b16 v[128:129], v32 offset:32768
    ds_read_b64_tr_b16 v[130:131], v32 offset:33792
    v_cvt_pk_bf16_f32 v237, v188, v189
    v_mul_f32 v184, v186, v178
    v_mul_f32 v185, v186, v179
    v_fma_f32 v184, -v187, v179, v184
    v_mfma_f32_32x32x16_bf16 v[80:95], v[144:147], v[156:159], v[80:95]
    ds_read_b128 v[140:143], v28 offset:36864
    ds_read_b64_tr_b16 v[132:133], v33 offset:32768
    ds_read_b64_tr_b16 v[134:135], v33 offset:33792
    s_add_u32 m0, s71, 98304
    s_add_u32 s86, s68, 384
    buffer_load_dwordx4 v16, s[40:43], s86 offen offset:0 lds
    v_mfma_f32_32x32x16_bf16 v[96:111], v[148:151], v[152:155], v[96:111]
    buffer_load_dwordx4 v17, s[40:43], s86 offen offset:1024 lds
    v_fmac_f32 v185, v187, v178
    v_mul_f32 v190, v188, v178
    v_mul_f32 v191, v188, v179
    v_fma_f32 v190, -v189, v179, v190
    v_fmac_f32 v191, v189, v178
    v_mfma_f32_32x32x16_bf16 v[112:127], v[148:151], v[156:159], v[112:127]
    buffer_load_dwordx4 v18, s[40:43], s86 offen offset:2048 lds
    v_cvt_pk_bf16_f32 v54, v184, v185
    v_cvt_pk_bf16_f32 v238, v190, v191
    v_mul_f32 v186, v184, v178
    v_mul_f32 v187, v184, v179
    v_mfma_f32_16x16x32_bf16 v[40:43], v[44:47], v[144:147], v[40:43]
    v_fma_f32 v186, -v185, v179, v186
    v_fmac_f32 v187, v185, v178
    s_waitcnt lgkmcnt(0)
    v_mfma_f32_32x32x16_bf16 v[64:79], v[128:131], v[136:139], v[64:79]
    ds_read_b128 v[152:155], v29 offset:32768
    ds_read_b64_tr_b16 v[144:145], v32 offset:36864
    ds_read_b64_tr_b16 v[146:147], v32 offset:37888
    v_mul_f32 v188, v190, v178
    v_mul_f32 v189, v190, v179
    v_fma_f32 v188, -v191, v179, v188
    v_fmac_f32 v189, v191, v178
    v_mfma_f32_32x32x16_bf16 v[80:95], v[128:131], v[140:143], v[80:95]
    ds_read_b128 v[156:159], v29 offset:36864
    ds_read_b64_tr_b16 v[148:149], v33 offset:36864
    ds_read_b64_tr_b16 v[150:151], v33 offset:37888
    buffer_load_dwordx4 v19, s[40:43], s86 offen offset:3072 lds
    v_mfma_f32_32x32x16_bf16 v[96:111], v[132:135], v[136:139], v[96:111]
    s_add_u32 m0, s72, 98304
    s_add_u32 s86, s69, 688128
    buffer_load_dwordx4 v20, s[44:47], s86 offen offset:0 lds
    v_cvt_pk_bf16_f32 v55, v186, v187
    v_cvt_pk_bf16_f32 v239, v188, v189
    v_mul_f32 v184, v186, v178
    v_mul_f32 v185, v186, v179
    v_mfma_f32_32x32x16_bf16 v[112:127], v[132:135], v[140:143], v[112:127]
    buffer_load_dwordx4 v21, s[44:47], s86 offen offset:1024 lds
    v_fma_f32 v184, -v187, v179, v184
    v_fmac_f32 v185, v187, v178
    v_mul_f32 v190, v188, v178
    v_mul_f32 v191, v188, v179
    v_fma_f32 v190, -v189, v179, v190
    v_mfma_f32_16x16x32_bf16 v[40:43], v[44:47], v[128:131], v[40:43]
    v_fmac_f32 v191, v189, v178
    v_cvt_pk_bf16_f32 v56, v184, v185
    s_waitcnt lgkmcnt(0)
    v_mfma_f32_32x32x16_bf16 v[64:79], v[144:147], v[152:155], v[64:79]
    ds_read_b128 v[136:139], v30 offset:32768
    ds_read_b64_tr_b16 v[128:129], v32 offset:40960
    ds_read_b64_tr_b16 v[130:131], v32 offset:41984
    v_cvt_pk_bf16_f32 v240, v190, v191
    v_mul_f32 v186, v184, v178
    v_mul_f32 v187, v184, v179
    v_fma_f32 v186, -v185, v179, v186
    v_mfma_f32_32x32x16_bf16 v[80:95], v[144:147], v[156:159], v[80:95]
    ds_read_b128 v[140:143], v30 offset:36864
    ds_read_b64_tr_b16 v[132:133], v33 offset:40960
    ds_read_b64_tr_b16 v[134:135], v33 offset:41984
    buffer_load_dwordx4 v22, s[44:47], s86 offen offset:2048 lds
    v_mfma_f32_32x32x16_bf16 v[96:111], v[148:151], v[152:155], v[96:111]
    buffer_load_dwordx4 v23, s[44:47], s86 offen offset:3072 lds
    v_fmac_f32 v187, v185, v178
    v_mul_f32 v188, v190, v178
    v_mul_f32 v189, v190, v179
    v_fma_f32 v188, -v191, v179, v188
    v_fmac_f32 v189, v191, v178
    v_mfma_f32_32x32x16_bf16 v[112:127], v[148:151], v[156:159], v[112:127]
    global_load_dwordx4 v[248:251], v255, s[28:29] offset:0
    v_cvt_pk_bf16_f32 v57, v186, v187
    v_cvt_pk_bf16_f32 v241, v188, v189
    v_mul_f32 v184, v186, v178
    v_mul_f32 v185, v186, v179
    v_mfma_f32_16x16x32_bf16 v[40:43], v[44:47], v[144:147], v[40:43]
    v_fma_f32 v184, -v187, v179, v184
    v_fmac_f32 v185, v187, v178
    s_waitcnt lgkmcnt(0)
    v_mfma_f32_32x32x16_bf16 v[64:79], v[128:131], v[136:139], v[64:79]
    ds_read_b128 v[152:155], v31 offset:32768
    ds_read_b64_tr_b16 v[144:145], v32 offset:45056
    ds_read_b64_tr_b16 v[146:147], v32 offset:46080
    v_mul_f32 v190, v188, v178
    v_mul_f32 v191, v188, v179
    v_fma_f32 v190, -v189, v179, v190
    v_fmac_f32 v191, v189, v178
    v_mfma_f32_32x32x16_bf16 v[80:95], v[128:131], v[140:143], v[80:95]
    ds_read_b128 v[156:159], v31 offset:36864
    ds_read_b64_tr_b16 v[148:149], v33 offset:45056
    ds_read_b64_tr_b16 v[150:151], v33 offset:46080
    global_load_dwordx4 v[248:251], v254, s[28:29] offset:0
    v_mfma_f32_32x32x16_bf16 v[96:111], v[132:135], v[136:139], v[96:111]
    s_add_u32 m0, s71, 0
    s_add_u32 s86, s68, 512
    buffer_load_dwordx4 v16, s[40:43], s86 offen offset:0 lds
    v_cvt_pk_bf16_f32 v58, v184, v185
    v_cvt_pk_bf16_f32 v242, v190, v191
    v_mul_f32 v186, v184, v178
    v_mul_f32 v187, v184, v179
    v_mfma_f32_32x32x16_bf16 v[112:127], v[132:135], v[140:143], v[112:127]
    buffer_load_dwordx4 v17, s[40:43], s86 offen offset:1024 lds
    v_fma_f32 v186, -v185, v179, v186
    v_fmac_f32 v187, v185, v178
    v_mul_f32 v188, v190, v178
    v_mul_f32 v189, v190, v179
    v_fma_f32 v188, -v191, v179, v188
    v_mfma_f32_16x16x32_bf16 v[40:43], v[44:47], v[128:131], v[40:43]
    v_fmac_f32 v189, v191, v178
    v_cvt_pk_bf16_f32 v59, v186, v187
    s_waitcnt vmcnt(12) lgkmcnt(0)
    s_barrier
    v_mfma_f32_32x32x16_bf16 v[64:79], v[144:147], v[152:155], v[64:79]
    ds_read_b128 v[136:139], v34 offset:0
    ds_read_b64_tr_b16 v[128:129], v38 offset:0
    ds_read_b64_tr_b16 v[130:131], v38 offset:1024
    v_cvt_pk_bf16_f32 v243, v188, v189
    v_mul_f32 v184, v186, v178
    v_mul_f32 v185, v186, v179
    v_fma_f32 v184, -v187, v179, v184
    v_mfma_f32_32x32x16_bf16 v[80:95], v[144:147], v[156:159], v[80:95]
    ds_read_b128 v[140:143], v34 offset:4096
    ds_read_b64_tr_b16 v[132:133], v39 offset:0
    ds_read_b64_tr_b16 v[134:135], v39 offset:1024
    buffer_load_dwordx4 v18, s[40:43], s86 offen offset:2048 lds
    v_mfma_f32_32x32x16_bf16 v[96:111], v[148:151], v[152:155], v[96:111]
    buffer_load_dwordx4 v19, s[40:43], s86 offen offset:3072 lds
    v_fmac_f32 v185, v187, v178
    v_mul_f32 v190, v188, v178
    v_mul_f32 v191, v188, v179
    v_fma_f32 v190, -v189, v179, v190
    v_fmac_f32 v191, v189, v178
    v_mfma_f32_32x32x16_bf16 v[112:127], v[148:151], v[156:159], v[112:127]
    s_add_u32 m0, s72, 0
    s_add_u32 s86, s69, 917504
    buffer_load_dwordx4 v20, s[44:47], s86 offen offset:0 lds
    v_cvt_pk_bf16_f32 v60, v184, v185
    v_cvt_pk_bf16_f32 v244, v190, v191
    v_mul_f32 v186, v184, v178
    v_mul_f32 v187, v184, v179
    v_mfma_f32_16x16x32_bf16 v[40:43], v[44:47], v[144:147], v[40:43]
    v_fma_f32 v186, -v185, v179, v186
    v_fmac_f32 v187, v185, v178
    s_waitcnt lgkmcnt(0)
    v_mfma_f32_32x32x16_bf16 v[64:79], v[128:131], v[136:139], v[64:79]
    ds_read_b128 v[152:155], v35 offset:0
    ds_read_b64_tr_b16 v[144:145], v38 offset:4096
    ds_read_b64_tr_b16 v[146:147], v38 offset:5120
    v_mul_f32 v188, v190, v178
    v_mul_f32 v189, v190, v179
    v_fma_f32 v188, -v191, v179, v188
    v_fmac_f32 v189, v191, v178
    v_mfma_f32_32x32x16_bf16 v[80:95], v[128:131], v[140:143], v[80:95]
    ds_read_b128 v[156:159], v35 offset:4096
    ds_read_b64_tr_b16 v[148:149], v39 offset:4096
    ds_read_b64_tr_b16 v[150:151], v39 offset:5120
    buffer_load_dwordx4 v21, s[44:47], s86 offen offset:1024 lds
    v_mfma_f32_32x32x16_bf16 v[96:111], v[132:135], v[136:139], v[96:111]
    buffer_load_dwordx4 v22, s[44:47], s86 offen offset:2048 lds
    v_cvt_pk_bf16_f32 v61, v186, v187
    v_cvt_pk_bf16_f32 v245, v188, v189
    v_mul_f32 v184, v186, v178
    v_mul_f32 v185, v186, v179
    v_mfma_f32_32x32x16_bf16 v[112:127], v[132:135], v[140:143], v[112:127]
    buffer_load_dwordx4 v23, s[44:47], s86 offen offset:3072 lds
    v_fma_f32 v184, -v187, v179, v184
    v_fmac_f32 v185, v187, v178
    v_mul_f32 v190, v188, v178
    v_mul_f32 v191, v188, v179
    v_fma_f32 v190, -v189, v179, v190
    v_mfma_f32_16x16x32_bf16 v[40:43], v[44:47], v[128:131], v[40:43]
    v_fmac_f32 v191, v189, v178
    v_cvt_pk_bf16_f32 v62, v184, v185
    s_waitcnt lgkmcnt(0)
    v_mfma_f32_32x32x16_bf16 v[64:79], v[144:147], v[152:155], v[64:79]
    ds_read_b128 v[136:139], v36 offset:0
    ds_read_b64_tr_b16 v[128:129], v38 offset:8192
    ds_read_b64_tr_b16 v[130:131], v38 offset:9216
    v_cvt_pk_bf16_f32 v246, v190, v191
    v_mul_f32 v186, v184, v178
    v_mul_f32 v187, v184, v179
    v_fma_f32 v186, -v185, v179, v186
    v_mfma_f32_32x32x16_bf16 v[80:95], v[144:147], v[156:159], v[80:95]
    ds_read_b128 v[140:143], v36 offset:4096
    ds_read_b64_tr_b16 v[132:133], v39 offset:8192
    ds_read_b64_tr_b16 v[134:135], v39 offset:9216
    s_add_u32 m0, s71, 32768
    s_add_u32 s86, s68, 640
    buffer_load_dwordx4 v16, s[40:43], s86 offen offset:0 lds
    v_mfma_f32_32x32x16_bf16 v[96:111], v[148:151], v[152:155], v[96:111]
    buffer_load_dwordx4 v17, s[40:43], s86 offen offset:1024 lds
    v_fmac_f32 v187, v185, v178
    v_mul_f32 v188, v190, v178
    v_mul_f32 v189, v190, v179
    v_fma_f32 v188, -v191, v179, v188
    v_fmac_f32 v189, v191, v178
    v_mfma_f32_32x32x16_bf16 v[112:127], v[148:151], v[156:159], v[112:127]
    buffer_load_dwordx4 v18, s[40:43], s86 offen offset:2048 lds
    v_cvt_pk_bf16_f32 v63, v186, v187
    v_cvt_pk_bf16_f32 v247, v188, v189
    s_mul_i32 s87, s85, 9280
    s_mul_i32 s74, s84, 4640
    s_add_u32 s87, s87, s74
    v_mfma_f32_16x16x32_bf16 v[40:43], v[44:47], v[144:147], v[40:43]
    s_add_u32 s87, s87, 98304
    s_mul_i32 s88, s61, 4224
    s_waitcnt lgkmcnt(0)
    v_mfma_f32_32x32x16_bf16 v[64:79], v[128:131], v[136:139], v[64:79]
    ds_read_b128 v[152:155], v37 offset:0
    ds_read_b64_tr_b16 v[144:145], v38 offset:12288
    ds_read_b64_tr_b16 v[146:147], v38 offset:13312
    s_lshl_b32 s74, s84, 2
    s_sub_u32 s88, s88, s74
    s_add_u32 s88, s88, 117876
    s_and_b32 s89, s2, 7
    s_lshl_b32 s89, s89, 9
    v_mfma_f32_32x32x16_bf16 v[80:95], v[128:131], v[140:143], v[80:95]
    ds_read_b128 v[156:159], v37 offset:4096
    ds_read_b64_tr_b16 v[148:149], v39 offset:12288
    ds_read_b64_tr_b16 v[150:151], v39 offset:13312
    buffer_load_dwordx4 v19, s[40:43], s86 offen offset:3072 lds
    v_mfma_f32_32x32x16_bf16 v[96:111], v[132:135], v[136:139], v[96:111]
    s_add_u32 m0, s72, 32768
    s_add_u32 s86, s69, 1146880
    buffer_load_dwordx4 v20, s[44:47], s86 offen offset:0 lds
    s_add_u32 s89, s89, 65536
    s_lshl_b32 s74, s61, 24
    s_add_u32 s89, s89, s74
    s_lshl_b32 s74, s2, 1
    s_add_u32 s74, s74, s85
    s_mul_i32 s74, s74, 4224
    v_mfma_f32_32x32x16_bf16 v[112:127], v[132:135], v[140:143], v[112:127]
    buffer_load_dwordx4 v21, s[44:47], s86 offen offset:1024 lds
    s_lshl_b32 s75, s84, 1
    s_add_u32 s74, s74, s75
    s_add_u32 s6, s74, 131198
    s_add_u32 s18, s73, 131072
    s_mov_b32 s92, 0xaaaaaaaa
    s_mov_b32 s93, 0xaaaaaaaa
    v_mfma_f32_16x16x32_bf16 v[40:43], v[44:47], v[128:131], v[40:43]
    v_lshlrev_b32 v8, 4, v1
    v_bfe_u32 v3, v1, 2, 2
    s_waitcnt vmcnt(16) lgkmcnt(0)
    s_barrier
    v_mfma_f32_32x32x16_bf16 v[64:79], v[144:147], v[152:155], v[64:79]
    ds_read_b128 v[136:139], v34 offset:32768
    ds_read_b64_tr_b16 v[128:129], v38 offset:32768
    ds_read_b64_tr_b16 v[130:131], v38 offset:33792
    v_lshrrev_b32 v4, 5, v1
    v_lshl_add_u32 v4, v4, 2, v3
    v_lshlrev_b32 v4, 7, v4
    v_lshrrev_b32 v3, 1, v3
    v_mfma_f32_32x32x16_bf16 v[80:95], v[144:147], v[156:159], v[80:95]
    ds_read_b128 v[140:143], v34 offset:36864
    ds_read_b64_tr_b16 v[132:133], v39 offset:32768
    ds_read_b64_tr_b16 v[134:135], v39 offset:33792
    buffer_load_dwordx4 v22, s[44:47], s86 offen offset:2048 lds
    v_mfma_f32_32x32x16_bf16 v[96:111], v[148:151], v[152:155], v[96:111]
    buffer_load_dwordx4 v23, s[44:47], s86 offen offset:3072 lds
    v_xor_b32 v3, s85, v3
    v_lshl_add_u32 v4, v3, 6, v4
    v_bfe_u32 v3, v1, 4, 1
    v_lshl_add_u32 v4, v3, 5, v4
    v_mfma_f32_32x32x16_bf16 v[112:127], v[148:151], v[156:159], v[112:127]
    s_add_u32 m0, s71, 65536
    s_add_u32 s86, s68, 768
    buffer_load_dwordx4 v16, s[40:43], s86 offen offset:0 lds
    v_and_b32 v3, 3, v1
    v_lshl_add_u32 v4, v3, 3, v4
    v_add_u32 v11, s73, v4
    v_xor_b32 v12, 64, v11
    v_add_u32 v13, 0x10000, v11
    v_mfma_f32_16x16x32_bf16 v[40:43], v[44:47], v[144:147], v[40:43]
    v_add_u32 v14, 0x10000, v12
    v_and_b32 v3, 1, v1
    s_waitcnt lgkmcnt(0)
    v_mfma_f32_32x32x16_bf16 v[64:79], v[128:131], v[136:139], v[64:79]
    ds_read_b128 v[152:155], v35 offset:32768
    ds_read_b64_tr_b16 v[144:145], v38 offset:36864
    ds_read_b64_tr_b16 v[146:147], v38 offset:37888
    v_and_b32 v2, 15, v1
    v_and_b32 v4, 0x30, v1
    v_mul_u32_u24 v5, 4220, v3
    v_add_u32 v5, v5, v4
    v_mfma_f32_32x32x16_bf16 v[80:95], v[128:131], v[140:143], v[80:95]
    ds_read_b128 v[156:159], v35 offset:36864
    ds_read_b64_tr_b16 v[148:149], v39 offset:36864
    ds_read_b64_tr_b16 v[150:151], v39 offset:37888
    buffer_load_dwordx4 v17, s[40:43], s86 offen offset:1024 lds
    v_mfma_f32_32x32x16_bf16 v[96:111], v[132:135], v[136:139], v[96:111]
    buffer_load_dwordx4 v18, s[40:43], s86 offen offset:2048 lds
    v_lshlrev_b32 v6, 2, v2
    v_sub_u32 v5, v5, v6
    s_mul_i32 s74, s85, 8448
    s_lshl_b32 s75, s84, 8
    s_sub_u32 s74, s74, s75
    s_add_u32 s74, s74, 117184
    v_mfma_f32_32x32x16_bf16 v[112:127], v[132:135], v[140:143], v[112:127]
    buffer_load_dwordx4 v19, s[40:43], s86 offen offset:3072 lds
    v_add_u32 v9, s74, v5
    v_mul_u32_u24 v5, 4640, v3
    v_add_u32 v5, v5, v4
    v_lshrrev_b32 v6, 1, v2
    v_lshl_add_u32 v5, v6, 6, v5
    v_mfma_f32_16x16x32_bf16 v[40:43], v[44:47], v[128:131], v[40:43]
    s_mul_i32 s74, s85, 9280
    s_sub_u32 s74, s74, s75
    s_waitcnt lgkmcnt(0)
    v_mfma_f32_32x32x16_bf16 v[64:79], v[144:147], v[152:155], v[64:79]
    ds_read_b128 v[136:139], v36 offset:32768
    ds_read_b64_tr_b16 v[128:129], v38 offset:40960
    ds_read_b64_tr_b16 v[130:131], v38 offset:41984
    s_add_u32 s74, s74, 98624
    v_add_u32 v10, s74, v5
    v_lshlrev_b32 v7, 12, v4
    v_lshl_add_u32 v7, v2, 4, v7
    v_mfma_f32_32x32x16_bf16 v[80:95], v[144:147], v[156:159], v[80:95]
    ds_read_b128 v[140:143], v36 offset:36864
    ds_read_b64_tr_b16 v[132:133], v39 offset:40960
    ds_read_b64_tr_b16 v[134:135], v39 offset:41984
    s_lshl_b32 s74, s61, 19
    s_lshl_b32 s75, s2, 8
    s_add_u32 s74, s74, s75
    s_add_u32 s12, s74, 3145728
    s_add_u32 s13, s12, 262144
    v_mfma_f32_32x32x16_bf16 v[96:111], v[148:151], v[152:155], v[96:111]
    s_add_u32 m0, s72, 65536
    s_add_u32 s86, s69, 1376256
    buffer_load_dwordx4 v20, s[44:47], s86 offen offset:0 lds
    s_lshl_b32 s74, s61, 7
    s_lshl_b32 s7, s66, 9
    s_add_u32 s7, s7, s74
    s_add_u32 s7, s7, 32768
    v_min_u32 v6, 6, v1
    v_lshlrev_b32 v6, 2, v6
    v_mfma_f32_32x32x16_bf16 v[112:127], v[148:151], v[156:159], v[112:127]
    buffer_load_dwordx4 v21, s[44:47], s86 offen offset:1024 lds
    v_and_b32 v2, 31, v1
    v_lshlrev_b32 v5, 2, v2
    s_lshl_b32 s74, s66, 1
    s_add_u32 s82, s74, s84
    s_xor_b32 s76, s82, 1
    s_mul_i32 s77, s61, 28672
    v_mfma_f32_16x16x32_bf16 v[40:43], v[44:47], v[144:147], v[40:43]
    s_add_u32 s77, s77, 6291456
    s_mul_i32 s80, s82, 114688
    s_waitcnt lgkmcnt(0)
    v_mfma_f32_32x32x16_bf16 v[64:79], v[128:131], v[136:139], v[64:79]
    ds_read_b128 v[152:155], v37 offset:32768
    ds_read_b64_tr_b16 v[144:145], v38 offset:45056
    ds_read_b64_tr_b16 v[146:147], v38 offset:46080
    s_add_u32 s80, s80, s77
    s_mul_i32 s81, s76, 114688
    s_add_u32 s81, s81, s77
    s_lshl_b32 s16, s82, 8
    s_add_u32 s16, s16, 16384
    v_mfma_f32_32x32x16_bf16 v[80:95], v[128:131], v[140:143], v[80:95]
    ds_read_b128 v[156:159], v37 offset:36864
    ds_read_b64_tr_b16 v[148:149], v39 offset:45056
    ds_read_b64_tr_b16 v[150:151], v39 offset:46080
    s_lshl_b32 s74, s67, 7
    s_lshl_b32 s75, s85, 6
    s_add_u32 s74, s74, s75
    s_mov_b32 s19, s74
    s_lshl_b32 s83, s82, 15
    v_mfma_f32_32x32x16_bf16 v[96:111], v[132:135], v[136:139], v[96:111]
    buffer_load_dwordx4 v22, s[44:47], s86 offen offset:2048 lds
    s_add_u32 s83, s83, s74
    s_lshl_b32 s9, s66, 16
    s_lshl_b32 s74, s74, 6
    s_add_u32 s9, s9, s74
    s_lshl_b32 s74, s84, 7
    s_add_u32 s9, s9, s74
    v_mfma_f32_32x32x16_bf16 v[112:127], v[132:135], v[140:143], v[112:127]
    buffer_load_dwordx4 v23, s[44:47], s86 offen offset:3072 lds
    s_add_u32 s9, s9, 3145728
    s_lshl_b32 s10, s61, 11
    s_and_b32 s74, s2, 0xf0
    s_add_u32 s74, s74, s2
    s_lshl_b32 s74, s74, 2
    s_add_u32 s10, s10, s74
    v_mfma_f32_16x16x32_bf16 v[40:43], v[44:47], v[128:131], v[40:43]
    s_add_u32 s10, s10, 4096
    s_lshr_b32 s11, s66, 3
    s_waitcnt vmcnt(16) lgkmcnt(0)
    s_barrier
    v_mfma_f32_32x32x16_bf16 v[64:79], v[144:147], v[152:155], v[64:79]
    ds_read_b128 v[136:139], v28 offset:0
    ds_read_b64_tr_b16 v[128:129], v32 offset:0
    ds_read_b64_tr_b16 v[130:131], v32 offset:1024
    s_lshl_b32 s11, s11, 11
    s_lshl_b32 s74, s19, 1
    s_add_u32 s11, s11, s74
    s_add_u32 s11, s11, 4096
    v_lshlrev_b32 v194, 2, v1
    v_mfma_f32_32x32x16_bf16 v[80:95], v[144:147], v[156:159], v[80:95]
    ds_read_b128 v[140:143], v28 offset:4096
    ds_read_b64_tr_b16 v[132:133], v33 offset:0
    ds_read_b64_tr_b16 v[134:135], v33 offset:1024
    v_add_u32 v194, s18, v194
    v_and_b32 v2, 31, v1
    v_and_b32 v3, 15, v1
    v_lshrrev_b32 v4, 5, v1
    v_mfma_f32_32x32x16_bf16 v[96:111], v[148:151], v[152:155], v[96:111]
    s_add_u32 m0, s71, 98304
    s_add_u32 s86, s68, 896
    buffer_load_dwordx4 v16, s[40:43], s86 offen offset:0 lds
    v_xor_b32 v3, v3, v4
    v_lshlrev_b32 v3, 4, v3
    v_lshl_add_u32 v2, v2, 8, v3
    v_add_u32 v223, s18, v2
    v_xor_b32 v224, 32, v223
    v_mfma_f32_32x32x16_bf16 v[112:127], v[148:151], v[156:159], v[112:127]
    buffer_load_dwordx4 v17, s[40:43], s86 offen offset:1024 lds
    v_xor_b32 v225, 64, v223
    v_xor_b32 v226, 96, v223
    v_xor_b32 v227, 128, v223
    v_xor_b32 v228, 160, v223
    v_xor_b32 v229, 192, v223
    v_mfma_f32_16x16x32_bf16 v[40:43], v[44:47], v[144:147], v[40:43]
    v_xor_b32 v230, 224, v223
    s_lshl_b32 s74, s64, 1
    s_waitcnt lgkmcnt(0)
    v_mfma_f32_32x32x16_bf16 v[64:79], v[128:131], v[136:139], v[64:79]
    ds_read_b128 v[152:155], v29 offset:0
    ds_read_b64_tr_b16 v[144:145], v32 offset:4096
    ds_read_b64_tr_b16 v[146:147], v32 offset:5120
    s_add_u32 s74, s74, s84
    s_lshl_b32 s15, s74, 9
    s_add_u32 s15, s15, 16384
    s_lshl_b32 s75, s65, 1
    s_add_u32 s75, s75, s85
    v_mfma_f32_32x32x16_bf16 v[80:95], v[128:131], v[140:143], v[80:95]
    ds_read_b128 v[156:159], v29 offset:4096
    ds_read_b64_tr_b16 v[148:149], v33 offset:4096
    ds_read_b64_tr_b16 v[150:151], v33 offset:5120
    s_mul_i32 s14, s74, 229376
    s_lshl_b32 s76, s75, 12
    s_add_u32 s14, s14, s76
    s_add_u32 s14, s14, 6291456
    s_mul_i32 s76, s75, 37
    v_mfma_f32_32x32x16_bf16 v[96:111], v[132:135], v[136:139], v[96:111]
    buffer_load_dwordx4 v18, s[40:43], s86 offen offset:2048 lds
    s_lshr_b32 s76, s76, 8
    s_mul_i32 s76, s76, 25
    s_add_u32 s75, s75, s76
    s_lshl_b32 s8, s74, 9
    s_lshl_b32 s75, s75, 2
    s_add_u32 s8, s8, s75
    v_mfma_f32_32x32x16_bf16 v[112:127], v[132:135], v[140:143], v[112:127]
    buffer_load_dwordx4 v19, s[40:43], s86 offen offset:3072 lds
    s_add_u32 s8, s8, 32768
    v_exp_f32 v167, v160
    v_fract_f32 v168, v161
    v_cos_f32 v169, v168
    v_mfma_f32_16x16x32_bf16 v[40:43], v[44:47], v[128:131], v[40:43]
    v_sin_f32 v170, v168
    s_waitcnt lgkmcnt(0)
    v_mfma_f32_32x32x16_bf16 v[64:79], v[144:147], v[152:155], v[64:79]
    ds_read_b128 v[136:139], v30 offset:0
    ds_read_b64_tr_b16 v[128:129], v32 offset:8192
    ds_read_b64_tr_b16 v[130:131], v32 offset:9216
    v_mul_f32 v172, v167, v169
    v_mul_f32 v173, v167, v170
    v_mul_f32 v167, 0x43800000, v160
    v_mul_f32 v168, 0x43800000, v161
    v_mfma_f32_32x32x16_bf16 v[80:95], v[144:147], v[156:159], v[80:95]
    ds_read_b128 v[140:143], v30 offset:4096
    ds_read_b64_tr_b16 v[132:133], v33 offset:8192
    ds_read_b64_tr_b16 v[134:135], v33 offset:9216
    v_exp_f32 v167, v167
    v_fract_f32 v168, v168
    v_cos_f32 v169, v168
    v_mfma_f32_32x32x16_bf16 v[96:111], v[148:151], v[152:155], v[96:111]
    s_add_u32 m0, s72, 98304
    s_add_u32 s86, s69, 1605632
    buffer_load_dwordx4 v20, s[44:47], s86 offen offset:0 lds
    v_sin_f32 v170, v168
    v_mul_f32 v180, v167, v169
    v_mul_f32 v181, v167, v170
    v_mul_f32 v182, v164, v162
    v_mfma_f32_32x32x16_bf16 v[112:127], v[148:151], v[156:159], v[112:127]
    buffer_load_dwordx4 v21, s[44:47], s86 offen offset:1024 lds
    v_mul_f32 v183, v164, v163
    v_fma_f32 v182, -v165, v163, v182
    v_fmac_f32 v183, v165, v162
    v_mul_f32 v174, v172, v172
    v_mul_f32 v175, v172, v173
    v_mfma_f32_16x16x32_bf16 v[40:43], v[44:47], v[144:147], v[40:43]
    v_fma_f32 v174, -v173, v173, v174
    v_fmac_f32 v175, v173, v172
    s_waitcnt lgkmcnt(0)
    v_mfma_f32_32x32x16_bf16 v[64:79], v[128:131], v[136:139], v[64:79]
    ds_read_b128 v[152:155], v31 offset:0
    ds_read_b64_tr_b16 v[144:145], v32 offset:12288
    ds_read_b64_tr_b16 v[146:147], v32 offset:13312
    v_mul_f32 v176, v174, v174
    v_mul_f32 v177, v174, v175
    v_fma_f32 v176, -v175, v175, v176
    v_fmac_f32 v177, v175, v174
    v_mfma_f32_32x32x16_bf16 v[80:95], v[128:131], v[140:143], v[80:95]
    ds_read_b128 v[156:159], v31 offset:4096
    ds_read_b64_tr_b16 v[148:149], v33 offset:12288
    ds_read_b64_tr_b16 v[150:151], v33 offset:13312
    v_cvt_pk_bf16_f32 v196, v182, -v183
    v_mul_f32 v184, v182, v172
    v_mul_f32 v185, v182, v173
    v_fma_f32 v184, -v183, v173, v184
    v_mfma_f32_32x32x16_bf16 v[96:111], v[132:135], v[136:139], v[96:111]
    buffer_load_dwordx4 v22, s[44:47], s86 offen offset:2048 lds
    v_fmac_f32 v185, v183, v172
    v_cvt_pk_bf16_f32 v197, v184, -v185
    v_mul_f32 v186, v184, v172
    v_mul_f32 v187, v184, v173
    v_fma_f32 v186, -v185, v173, v186
    v_mfma_f32_32x32x16_bf16 v[112:127], v[132:135], v[140:143], v[112:127]
    buffer_load_dwordx4 v23, s[44:47], s86 offen offset:3072 lds
    v_fmac_f32 v187, v185, v172
    v_cvt_pk_bf16_f32 v198, v186, -v187
    v_mul_f32 v184, v186, v172
    v_mul_f32 v185, v186, v173
    v_fma_f32 v184, -v187, v173, v184
    v_mfma_f32_16x16x32_bf16 v[40:43], v[44:47], v[128:131], v[40:43]
    v_fmac_f32 v185, v187, v172
    v_cvt_pk_bf16_f32 v199, v184, -v185
    s_waitcnt vmcnt(16) lgkmcnt(0)
    s_barrier
    v_mfma_f32_32x32x16_bf16 v[64:79], v[144:147], v[152:155], v[64:79]
    ds_read_b128 v[136:139], v28 offset:32768
    ds_read_b64_tr_b16 v[128:129], v32 offset:32768
    ds_read_b64_tr_b16 v[130:131], v32 offset:33792
    v_mul_f32 v186, v184, v172
    v_mul_f32 v187, v184, v173
    v_fma_f32 v186, -v185, v173, v186
    v_fmac_f32 v187, v185, v172
    v_mfma_f32_32x32x16_bf16 v[80:95], v[144:147], v[156:159], v[80:95]
    ds_read_b128 v[140:143], v28 offset:36864
    ds_read_b64_tr_b16 v[132:133], v33 offset:32768
    ds_read_b64_tr_b16 v[134:135], v33 offset:33792
    v_cvt_pk_bf16_f32 v200, v186, -v187
    v_mul_f32 v184, v186, v172
    v_mul_f32 v185, v186, v173
    v_fma_f32 v184, -v187, v173, v184
    v_mfma_f32_32x32x16_bf16 v[96:111], v[148:151], v[152:155], v[96:111]
    s_add_u32 m0, s73, 0
    s_add_u32 s86, s70, 0
    buffer_load_dwordx4 v24, s[48:51], s86 offen offset:0 lds
    v_fmac_f32 v185, v187, v172
    v_cvt_pk_bf16_f32 v201, v184, -v185
    v_mul_f32 v186, v184, v172
    v_mul_f32 v187, v184, v173
    v_fma_f32 v186, -v185, v173, v186
    v_mfma_f32_32x32x16_bf16 v[112:127], v[148:151], v[156:159], v[112:127]
    buffer_load_dwordx4 v25, s[48:51], s86 offen offset:1024 lds
    v_fmac_f32 v187, v185, v172
    v_cvt_pk_bf16_f32 v202, v186, -v187
    v_mul_f32 v184, v186, v172
    v_mul_f32 v185, v186, v173
    v_fma_f32 v184, -v187, v173, v184
    v_mfma_f32_16x16x32_bf16 v[40:43], v[44:47], v[144:147], v[40:43]
    v_fmac_f32 v185, v187, v172
    v_cvt_pk_bf16_f32 v203, v184, -v185
    s_waitcnt lgkmcnt(0)
    v_mfma_f32_32x32x16_bf16 v[64:79], v[128:131], v[136:139], v[64:79]
    ds_read_b128 v[152:155], v29 offset:32768
    ds_read_b64_tr_b16 v[144:145], v32 offset:36864
    ds_read_b64_tr_b16 v[146:147], v32 offset:37888
    v_mul_f32 v188, v182, v180
    v_mul_f32 v189, v182, v181
    v_fma_f32 v188, -v183, v181, v188
    v_fmac_f32 v189, v183, v180
    v_mfma_f32_32x32x16_bf16 v[80:95], v[128:131], v[140:143], v[80:95]
    ds_read_b128 v[156:159], v29 offset:36864
    ds_read_b64_tr_b16 v[148:149], v33 offset:36864
    ds_read_b64_tr_b16 v[150:151], v33 offset:37888
    v_cvt_pk_bf16_f32 v204, v188, -v189
    v_mul_f32 v184, v188, v174
    v_mul_f32 v185, v188, v175
    v_fma_f32 v184, -v189, v175, v184
    v_mfma_f32_32x32x16_bf16 v[96:111], v[132:135], v[136:139], v[96:111]
    buffer_load_dwordx4 v26, s[48:51], s86 offen offset:2048 lds
    v_fmac_f32 v185, v189, v174
    v_cvt_pk_bf16_f32 v205, v184, -v185
    v_mul_f32 v186, v184, v174
    v_mul_f32 v187, v184, v175
    v_fma_f32 v186, -v185, v175, v186
    v_mfma_f32_32x32x16_bf16 v[112:127], v[132:135], v[140:143], v[112:127]
    buffer_load_dwordx4 v27, s[48:51], s86 offen offset:3072 lds
    v_fmac_f32 v187, v185, v174
    v_cvt_pk_bf16_f32 v206, v186, -v187
    v_mul_f32 v184, v186, v174
    v_mul_f32 v185, v186, v175
    v_fma_f32 v184, -v187, v175, v184
    v_mfma_f32_16x16x32_bf16 v[40:43], v[44:47], v[128:131], v[40:43]
    v_fmac_f32 v185, v187, v174
    v_cvt_pk_bf16_f32 v207, v184, -v185
    s_waitcnt lgkmcnt(0)
    v_mfma_f32_32x32x16_bf16 v[64:79], v[144:147], v[152:155], v[64:79]
    ds_read_b128 v[136:139], v30 offset:32768
    ds_read_b64_tr_b16 v[128:129], v32 offset:40960
    ds_read_b64_tr_b16 v[130:131], v32 offset:41984
    v_mul_f32 v186, v184, v174
    v_mul_f32 v187, v184, v175
    v_fma_f32 v186, -v185, v175, v186
    v_fmac_f32 v187, v185, v174
    v_mfma_f32_32x32x16_bf16 v[80:95], v[144:147], v[156:159], v[80:95]
    ds_read_b128 v[140:143], v30 offset:36864
    ds_read_b64_tr_b16 v[132:133], v33 offset:40960
    ds_read_b64_tr_b16 v[134:135], v33 offset:41984
    v_cvt_pk_bf16_f32 v208, v186, -v187
    v_mul_f32 v190, v188, v180
    v_mul_f32 v191, v188, v181
    v_fma_f32 v190, -v189, v181, v190
    v_mfma_f32_32x32x16_bf16 v[96:111], v[148:151], v[152:155], v[96:111]
    s_add_u32 m0, s73, 4096
    s_add_u32 s86, s70, 32768
    buffer_load_dwordx4 v24, s[48:51], s86 offen offset:0 lds
    v_fmac_f32 v191, v189, v180
    v_cvt_pk_bf16_f32 v209, v190, -v191
    v_mul_f32 v184, v190, v176
    v_mul_f32 v185, v190, v177
    v_fma_f32 v184, -v191, v177, v184
    v_mfma_f32_32x32x16_bf16 v[112:127], v[148:151], v[156:159], v[112:127]
    buffer_load_dwordx4 v25, s[48:51], s86 offen offset:1024 lds
    v_fmac_f32 v185, v191, v176
    v_cvt_pk_bf16_f32 v210, v184, -v185
    v_mul_f32 v186, v184, v176
    v_mul_f32 v187, v184, v177
    v_fma_f32 v186, -v185, v177, v186
    v_mfma_f32_16x16x32_bf16 v[40:43], v[44:47], v[144:147], v[40:43]
    v_fmac_f32 v187, v185, v176
    v_cvt_pk_bf16_f32 v211, v186, -v187
    s_waitcnt lgkmcnt(0)
    v_mfma_f32_32x32x16_bf16 v[64:79], v[128:131], v[136:139], v[64:79]
    ds_read_b128 v[152:155], v31 offset:32768
    ds_read_b64_tr_b16 v[144:145], v32 offset:45056
    ds_read_b64_tr_b16 v[146:147], v32 offset:46080
    v_mul_f32 v188, v190, v180
    v_mul_f32 v189, v190, v181
    v_fma_f32 v188, -v191, v181, v188
    v_fmac_f32 v189, v191, v180
    v_mfma_f32_32x32x16_bf16 v[80:95], v[128:131], v[140:143], v[80:95]
    ds_read_b128 v[156:159], v31 offset:36864
    ds_read_b64_tr_b16 v[148:149], v33 offset:45056
    ds_read_b64_tr_b16 v[150:151], v33 offset:46080
    v_cvt_pk_bf16_f32 v212, v188, -v189
    v_mul_f32 v184, v188, v176
    v_mul_f32 v185, v188, v177
    v_fma_f32 v184, -v189, v177, v184
    v_mfma_f32_32x32x16_bf16 v[96:111], v[132:135], v[136:139], v[96:111]
    buffer_load_dwordx4 v26, s[48:51], s86 offen offset:2048 lds
    v_fmac_f32 v185, v189, v176
    v_cvt_pk_bf16_f32 v213, v184, -v185
    v_mul_f32 v186, v184, v176
    v_mul_f32 v187, v184, v177
    v_fma_f32 v186, -v185, v177, v186
    v_mfma_f32_32x32x16_bf16 v[112:127], v[132:135], v[140:143], v[112:127]
    buffer_load_dwordx4 v27, s[48:51], s86 offen offset:3072 lds
    v_fmac_f32 v187, v185, v176
    v_cvt_pk_bf16_f32 v214, v186, -v187
    v_mul_f32 v190, v188, v180
    v_mul_f32 v191, v188, v181
    v_fma_f32 v190, -v189, v181, v190
    v_mfma_f32_16x16x32_bf16 v[40:43], v[44:47], v[128:131], v[40:43]
    v_fmac_f32 v191, v189, v180
    v_cvt_pk_bf16_f32 v215, v190, -v191
    s_waitcnt vmcnt(16) lgkmcnt(0)
    s_barrier
    v_mfma_f32_32x32x16_bf16 v[64:79], v[144:147], v[152:155], v[64:79]
    ds_read_b128 v[136:139], v34 offset:0
    ds_read_b64_tr_b16 v[128:129], v38 offset:0
    ds_read_b64_tr_b16 v[130:131], v38 offset:1024
    v_mul_f32 v184, v190, v178
    v_mul_f32 v185, v190, v179
    v_fma_f32 v184, -v191, v179, v184
    v_fmac_f32 v185, v191, v178
    v_mfma_f32_32x32x16_bf16 v[80:95], v[144:147], v[156:159], v[80:95]
    ds_read_b128 v[140:143], v34 offset:4096
    ds_read_b64_tr_b16 v[132:133], v39 offset:0
    ds_read_b64_tr_b16 v[134:135], v39 offset:1024
    v_cvt_pk_bf16_f32 v216, v184, -v185
    v_mul_f32 v188, v190, v180
    v_mul_f32 v189, v190, v181
    v_fma_f32 v188, -v191, v181, v188
    v_mfma_f32_32x32x16_bf16 v[96:111], v[148:151], v[152:155], v[96:111]
    s_add_u32 m0, s73, 32768
    s_add_u32 s86, s70, 65536
    buffer_load_dwordx4 v24, s[48:51], s86 offen offset:0 lds
    v_fmac_f32 v189, v191, v180
    v_cvt_pk_bf16_f32 v217, v188, -v189
    v_mul_f32 v184, v188, v178
    v_mul_f32 v185, v188, v179
    v_fma_f32 v184, -v189, v179, v184
    v_mfma_f32_32x32x16_bf16 v[112:127], v[148:151], v[156:159], v[112:127]
    buffer_load_dwordx4 v25, s[48:51], s86 offen offset:1024 lds
    v_fmac_f32 v185, v189, v178
    v_cvt_pk_bf16_f32 v218, v184, -v185
    v_mul_f32 v190, v188, v180
    v_mul_f32 v191, v188, v181
    v_fma_f32 v190, -v189, v181, v190
    v_mfma_f32_16x16x32_bf16 v[40:43], v[44:47], v[144:147], v[40:43]
    v_fmac_f32 v191, v189, v180
    v_cvt_pk_bf16_f32 v219, v190, -v191
    s_waitcnt lgkmcnt(0)
    v_mfma_f32_32x32x16_bf16 v[64:79], v[128:131], v[136:139], v[64:79]
    ds_read_b128 v[152:155], v35 offset:0
    ds_read_b64_tr_b16 v[144:145], v38 offset:4096
    ds_read_b64_tr_b16 v[146:147], v38 offset:5120
    v_mul_f32 v184, v190, v178
    v_mul_f32 v185, v190, v179
    v_fma_f32 v184, -v191, v179, v184
    v_fmac_f32 v185, v191, v178
    v_mfma_f32_32x32x16_bf16 v[80:95], v[128:131], v[140:143], v[80:95]
    ds_read_b128 v[156:159], v35 offset:4096
    ds_read_b64_tr_b16 v[148:149], v39 offset:4096
    ds_read_b64_tr_b16 v[150:151], v39 offset:5120
    v_cvt_pk_bf16_f32 v220, v184, -v185
    v_mul_f32 v188, v190, v180
    v_mul_f32 v189, v190, v181
    v_fma_f32 v188, -v191, v181, v188
    v_mfma_f32_32x32x16_bf16 v[96:111], v[132:135], v[136:139], v[96:111]
    buffer_load_dwordx4 v26, s[48:51], s86 offen offset:2048 lds
    v_fmac_f32 v189, v191, v180
    v_cvt_pk_bf16_f32 v221, v188, -v189
    v_mul_f32 v184, v188, v178
    v_mul_f32 v185, v188, v179
    v_fma_f32 v184, -v189, v179, v184
    v_mfma_f32_32x32x16_bf16 v[112:127], v[132:135], v[140:143], v[112:127]
    buffer_load_dwordx4 v27, s[48:51], s86 offen offset:3072 lds
    v_fmac_f32 v185, v189, v178
    v_cvt_pk_bf16_f32 v222, v184, -v185
    v_mov_b32 v188, 0
    v_mov_b32 v189, 0
    v_mov_b32 v190, 0
    v_mfma_f32_16x16x32_bf16 v[40:43], v[44:47], v[128:131], v[40:43]
    v_mov_b32 v191, 0
    v_and_b32 v169, 0x1f0, v8
    s_waitcnt lgkmcnt(0)
    v_mfma_f32_32x32x16_bf16 v[64:79], v[144:147], v[152:155], v[64:79]
    ds_read_b128 v[136:139], v36 offset:0
    ds_read_b64_tr_b16 v[128:129], v38 offset:8192
    ds_read_b64_tr_b16 v[130:131], v38 offset:9216
    v_add_u32 v169, s87, v169
    v_and_b32 v170, 60, v5
    v_add_u32 v170, s88, v170
    v_add_u32 v167, s18, v8
    v_mfma_f32_32x32x16_bf16 v[80:95], v[144:147], v[156:159], v[80:95]
    ds_read_b128 v[140:143], v36 offset:4096
    ds_read_b64_tr_b16 v[132:133], v39 offset:8192
    ds_read_b64_tr_b16 v[134:135], v39 offset:9216
    v_xor_b32 v168, 0x2000, v167
    v_sub_u32 v160, s88, v8
    v_add_u32 v161, 1024, v160
    v_add_u32 v162, 2048, v160
    v_mfma_f32_32x32x16_bf16 v[96:111], v[148:151], v[152:155], v[96:111]
    s_add_u32 m0, s73, 36864
    s_add_u32 s86, s70, 98304
    buffer_load_dwordx4 v24, s[48:51], s86 offen offset:0 lds
    v_add_u32 v163, 3072, v160
    v_mov_b32 v174, 0
    v_mov_b32 v175, 0
    v_mov_b32 v178, 0
    v_mov_b32 v179, 0
    v_mfma_f32_32x32x16_bf16 v[112:127], v[148:151], v[156:159], v[112:127]
    buffer_load_dwordx4 v25, s[48:51], s86 offen offset:1024 lds
    v_mov_b32 v182, 0
    v_mov_b32 v183, 0
    v_mov_b32 v186, 0
    v_mov_b32 v187, 0
    v_mfma_f32_16x16x32_bf16 v[40:43], v[44:47], v[144:147], v[40:43]
    s_waitcnt lgkmcnt(0)
    v_mfma_f32_32x32x16_bf16 v[64:79], v[128:131], v[136:139], v[64:79]
    ds_read_b128 v[152:155], v37 offset:0
    ds_read_b64_tr_b16 v[144:145], v38 offset:12288
    ds_read_b64_tr_b16 v[146:147], v38 offset:13312
    v_mfma_f32_32x32x16_bf16 v[80:95], v[128:131], v[140:143], v[80:95]
    ds_read_b128 v[156:159], v37 offset:4096
    ds_read_b64_tr_b16 v[148:149], v39 offset:12288
    ds_read_b64_tr_b16 v[150:151], v39 offset:13312
    v_mfma_f32_32x32x16_bf16 v[96:111], v[132:135], v[136:139], v[96:111]
    buffer_load_dwordx4 v26, s[48:51], s86 offen offset:2048 lds
    v_mfma_f32_32x32x16_bf16 v[112:127], v[132:135], v[140:143], v[112:127]
    buffer_load_dwordx4 v27, s[48:51], s86 offen offset:3072 lds
    v_mfma_f32_16x16x32_bf16 v[40:43], v[44:47], v[128:131], v[40:43]
    s_waitcnt vmcnt(16) lgkmcnt(0)
    s_barrier
    v_mfma_f32_32x32x16_bf16 v[64:79], v[144:147], v[152:155], v[64:79]
    ds_read_b128 v[136:139], v34 offset:32768
    ds_read_b64_tr_b16 v[128:129], v38 offset:32768
    ds_read_b64_tr_b16 v[130:131], v38 offset:33792
    s_waitcnt vmcnt(8)
    ds_read_b64_tr_b16 a[0:1], v11 offset:0
    ds_read_b64_tr_b16 a[2:3], v11 offset:1024
    ds_read_b64_tr_b16 a[4:5], v12 offset:0
    ds_read_b64_tr_b16 a[6:7], v12 offset:1024
    v_mfma_f32_32x32x16_bf16 v[80:95], v[144:147], v[156:159], v[80:95]
    ds_read_b128 v[140:143], v34 offset:36864
    ds_read_b64_tr_b16 v[132:133], v39 offset:32768
    ds_read_b64_tr_b16 v[134:135], v39 offset:33792
    ds_read_b64_tr_b16 a[8:9], v11 offset:2048
    ds_read_b64_tr_b16 a[10:11], v11 offset:3072
    ds_read_b64_tr_b16 a[12:13], v12 offset:2048
    ds_read_b64_tr_b16 a[14:15], v12 offset:3072
    v_mfma_f32_32x32x16_bf16 v[96:111], v[148:151], v[152:155], v[96:111]
    s_add_u32 m0, s73, 65536
    s_add_u32 s86, s70, 131072
    buffer_load_dwordx4 v24, s[48:51], s86 offen offset:0 lds
    ds_read_b64_tr_b16 a[16:17], v11 offset:4096
    ds_read_b64_tr_b16 a[18:19], v11 offset:5120
    ds_read_b64_tr_b16 a[20:21], v12 offset:4096
    ds_read_b64_tr_b16 a[22:23], v12 offset:5120
    ds_read_b64_tr_b16 a[24:25], v11 offset:6144
    v_mfma_f32_32x32x16_bf16 v[112:127], v[148:151], v[156:159], v[112:127]
    buffer_load_dwordx4 v25, s[48:51], s86 offen offset:1024 lds
    v_lshlrev_b32 v2, 3, v1
    buffer_load_dwordx2 v[164:165], v2, s[52:55], s15 offen sc1
    v_add_u32 v3, s73, v2
    ds_read_b64_tr_b16 a[26:27], v11 offset:7168
    ds_read_b64_tr_b16 a[28:29], v12 offset:6144
    ds_read_b64_tr_b16 a[30:31], v12 offset:7168
    v_mfma_f32_16x16x32_bf16 v[40:43], v[44:47], v[144:147], v[40:43]
    s_waitcnt lgkmcnt(12)
    v_mfma_f32_32x32x16_bf16 v[64:79], v[128:131], v[136:139], v[64:79]
    ds_read_b128 v[152:155], v35 offset:32768
    ds_read_b64_tr_b16 v[144:145], v38 offset:36864
    ds_read_b64_tr_b16 v[146:147], v38 offset:37888
    v_mfma_f32_32x32x16_bf16 v[80:95], v[128:131], v[140:143], v[80:95]
    ds_read_b128 v[156:159], v35 offset:36864
    ds_read_b64_tr_b16 v[148:149], v39 offset:36864
    ds_read_b64_tr_b16 v[150:151], v39 offset:37888
    v_mfma_f32_32x32x16_bf16 v[96:111], v[132:135], v[136:139], v[96:111]
    buffer_load_dwordx4 v26, s[48:51], s86 offen offset:2048 lds
    v_mfma_f32_32x32x16_bf16 v[112:127], v[132:135], v[140:143], v[112:127]
    buffer_load_dwordx4 v27, s[48:51], s86 offen offset:3072 lds
    v_mfma_f32_16x16x32_bf16 v[40:43], v[44:47], v[128:131], v[40:43]
    s_waitcnt lgkmcnt(0)
    v_mfma_f32_32x32x16_bf16 v[64:79], v[144:147], v[152:155], v[64:79]
    ds_read_b128 v[136:139], v36 offset:32768
    ds_read_b64_tr_b16 v[128:129], v38 offset:40960
    ds_read_b64_tr_b16 v[130:131], v38 offset:41984
    v_mfma_f32_32x32x16_bf16 v[80:95], v[144:147], v[156:159], v[80:95]
    ds_read_b128 v[140:143], v36 offset:36864
    ds_read_b64_tr_b16 v[132:133], v39 offset:40960
    ds_read_b64_tr_b16 v[134:135], v39 offset:41984
    v_mfma_f32_32x32x16_bf16 v[96:111], v[148:151], v[152:155], v[96:111]
    s_add_u32 m0, s73, 69632
    s_add_u32 s86, s70, 163840
    buffer_load_dwordx4 v24, s[48:51], s86 offen offset:0 lds
    v_mfma_f32_32x32x16_bf16 v[112:127], v[148:151], v[156:159], v[112:127]
    buffer_load_dwordx4 v25, s[48:51], s86 offen offset:1024 lds
    v_mfma_f32_16x16x32_bf16 v[40:43], v[44:47], v[144:147], v[40:43]
    s_waitcnt lgkmcnt(0)
    v_mfma_f32_32x32x16_bf16 v[64:79], v[128:131], v[136:139], v[64:79]
    ds_read_b128 v[152:155], v37 offset:32768
    ds_read_b64_tr_b16 v[144:145], v38 offset:45056
    ds_read_b64_tr_b16 v[146:147], v38 offset:46080
    s_waitcnt vmcnt(7)
    ds_read_b64_tr_b16 a[32:33], v11 offset:32768
    ds_read_b64_tr_b16 a[34:35], v11 offset:33792
    ds_read_b64_tr_b16 a[36:37], v12 offset:32768
    ds_read_b64_tr_b16 a[38:39], v12 offset:33792
    v_mfma_f32_32x32x16_bf16 v[80:95], v[128:131], v[140:143], v[80:95]
    ds_read_b128 v[156:159], v37 offset:36864
    ds_read_b64_tr_b16 v[148:149], v39 offset:45056
    ds_read_b64_tr_b16 v[150:151], v39 offset:46080
    ds_read_b64_tr_b16 a[40:41], v11 offset:34816
    ds_read_b64_tr_b16 a[42:43], v11 offset:35840
    ds_read_b64_tr_b16 a[44:45], v12 offset:34816
    ds_read_b64_tr_b16 a[46:47], v12 offset:35840
    v_mfma_f32_32x32x16_bf16 v[96:111], v[132:135], v[136:139], v[96:111]
    buffer_load_dwordx4 v26, s[48:51], s86 offen offset:2048 lds
    ds_read_b64_tr_b16 a[48:49], v11 offset:36864
    ds_read_b64_tr_b16 a[50:51], v11 offset:37888
    ds_read_b64_tr_b16 a[52:53], v12 offset:36864
    ds_read_b64_tr_b16 a[54:55], v12 offset:37888
    ds_read_b64_tr_b16 a[56:57], v11 offset:38912
    v_mfma_f32_32x32x16_bf16 v[112:127], v[132:135], v[140:143], v[112:127]
    buffer_load_dwordx4 v27, s[48:51], s86 offen offset:3072 lds
    buffer_load_dword v15, v5, s[52:55], s89 offen sc1
    ds_read_b64_tr_b16 a[58:59], v11 offset:39936
    ds_read_b64_tr_b16 a[60:61], v12 offset:38912
    ds_read_b64_tr_b16 a[62:63], v12 offset:39936
    v_mfma_f32_16x16x32_bf16 v[40:43], v[44:47], v[128:131], v[40:43]
    s_waitcnt lgkmcnt(12)
    v_mfma_f32_16x16x32_bf16 v[40:43], v[44:47], v[144:147], v[40:43]
    v_mfma_f32_32x32x16_bf16 v[64:79], v[144:147], v[152:155], v[64:79]
    v_mfma_f32_32x32x16_bf16 v[80:95], v[144:147], v[156:159], v[80:95]
    s_nop 5
    v_cvt_pk_bf16_f32 v176, v40, v40
    v_and_b32 v176, s78, v176
    v_sub_f32 v4, v40, v176
    v_cvt_pk_bf16_f32 v172, v176, v4
    v_and_b32 v176, s78, v172
    v_sub_f32 v4, v4, v176
    v_cvt_pk_bf16_f32 v173, v4, v171
    ds_write_b64 v3, v[172:173] offset:32768
    v_mfma_f32_32x32x16_bf16 v[96:111], v[148:151], v[152:155], v[96:111]
    v_xor_b32 v3, 0x2000, v3
    s_waitcnt vmcnt(7)
    s_mov_b32 s79, 0
L_pc1:
    v_cmp_ne_u32 vcc, s60, v165
    s_cbranch_vccz L_pd1
    s_add_u32 s79, s79, 1
    s_cmp_gt_u32 s79, 100000
    s_cbranch_scc1 L_pd1
    s_sleep 4
    buffer_load_dwordx2 v[164:165], v2, s[52:55], s15 offen offset:0 sc1
    s_waitcnt vmcnt(0)
    s_branch L_pc1
L_pd1:
    v_mov_b32 v181, v164
    v_mov_b32 v185, v164
    s_mov_b32 s74, 0x01000100
    v_mfma_f32_32x32x16_bf16 v[112:127], v[148:151], v[156:159], v[112:127]
    v_permlane32_swap_b32 v181, v185
    v_perm_b32 v180, v181, v181, s74
    v_perm_b32 v184, v185, v185, s74
    s_nop 0
    v_mfma_f32_32x32x16_bf16 v[64:79], v[172:175], v[180:183], v[64:79]
    ds_write2st64_b32 v194, v48, v232 offset0:0 offset1:16
    v_xor_b32 v195, 16, v194
    ds_write2st64_b32 v195, v49, v233 offset0:1 offset1:17
    v_mfma_f32_32x32x16_bf16 v[80:95], v[172:175], v[184:187], v[80:95]
    v_xor_b32 v195, 32, v194
    ds_write2st64_b32 v195, v50, v234 offset0:2 offset1:18
    v_xor_b32 v195, 48, v194
    ds_write2st64_b32 v195, v51, v235 offset0:3 offset1:19
    s_lshl_b32 s76, s84, 11
    s_add_u32 s74, s76, s14
    s_add_u32 s75, s74, 114688
    s_xor_b32 s76, s76, 2048
    s_add_u32 s76, s76, s14
    s_add_u32 s77, s76, 114688
    v_max_f32 v64, 0, v64
    v_max_f32 v65, 0, v65
    v_max_f32 v66, 0, v66
    v_max_f32 v67, 0, v67
    v_max_f32 v68, 0, v68
    v_max_f32 v69, 0, v69
    v_max_f32 v70, 0, v70
    v_max_f32 v71, 0, v71
    v_pk_mul_f32 v[64:65], v[64:65], v[64:65]
    v_pk_mul_f32 v[66:67], v[66:67], v[66:67]
    v_pk_mul_f32 v[68:69], v[68:69], v[68:69]
    v_pk_mul_f32 v[70:71], v[70:71], v[70:71]
    v_cvt_pk_bf16_f32 v128, v64, v65
    v_cvt_pk_bf16_f32 v129, v66, v67
    v_cvt_pk_bf16_f32 v130, v68, v69
    v_cvt_pk_bf16_f32 v131, v70, v71
    buffer_store_dwordx4 v[128:131], v8, s[52:55], s74 offen offset:0 sc1
    v_max_f32 v72, 0, v72
    v_max_f32 v73, 0, v73
    v_max_f32 v74, 0, v74
    v_max_f32 v75, 0, v75
    v_max_f32 v76, 0, v76
    v_max_f32 v77, 0, v77
    v_max_f32 v78, 0, v78
    v_max_f32 v79, 0, v79
    v_pk_mul_f32 v[72:73], v[72:73], v[72:73]
    v_pk_mul_f32 v[74:75], v[74:75], v[74:75]
    v_pk_mul_f32 v[76:77], v[76:77], v[76:77]
    v_pk_mul_f32 v[78:79], v[78:79], v[78:79]
    v_cvt_pk_bf16_f32 v132, v72, v73
    v_cvt_pk_bf16_f32 v133, v74, v75
    v_cvt_pk_bf16_f32 v134, v76, v77
    v_cvt_pk_bf16_f32 v135, v78, v79
    buffer_store_dwordx4 v[132:135], v8, s[52:55], s74 offen offset:1024 sc1
    v_max_f32 v80, 0, v80
    v_max_f32 v81, 0, v81
    v_max_f32 v82, 0, v82
    v_max_f32 v83, 0, v83
    v_max_f32 v84, 0, v84
    v_max_f32 v85, 0, v85
    v_max_f32 v86, 0, v86
    v_max_f32 v87, 0, v87
    v_pk_mul_f32 v[80:81], v[80:81], v[80:81]
    v_pk_mul_f32 v[82:83], v[82:83], v[82:83]
    v_pk_mul_f32 v[84:85], v[84:85], v[84:85]
    v_pk_mul_f32 v[86:87], v[86:87], v[86:87]
    v_cvt_pk_bf16_f32 v136, v80, v81
    v_cvt_pk_bf16_f32 v137, v82, v83
    v_cvt_pk_bf16_f32 v138, v84, v85
    v_cvt_pk_bf16_f32 v139, v86, v87
    buffer_store_dwordx4 v[136:139], v8, s[52:55], s75 offen offset:0 sc1
    v_max_f32 v88, 0, v88
    v_max_f32 v89, 0, v89
    v_max_f32 v90, 0, v90
    v_max_f32 v91, 0, v91
    v_max_f32 v92, 0, v92
    v_max_f32 v93, 0, v93
    v_max_f32 v94, 0, v94
    v_max_f32 v95, 0, v95
    v_pk_mul_f32 v[88:89], v[88:89], v[88:89]
    v_pk_mul_f32 v[90:91], v[90:91], v[90:91]
    v_pk_mul_f32 v[92:93], v[92:93], v[92:93]
    v_pk_mul_f32 v[94:95], v[94:95], v[94:95]
    v_cvt_pk_bf16_f32 v140, v88, v89
    v_cvt_pk_bf16_f32 v141, v90, v91
    v_cvt_pk_bf16_f32 v142, v92, v93
    v_cvt_pk_bf16_f32 v143, v94, v95
    buffer_store_dwordx4 v[140:143], v8, s[52:55], s75 offen offset:1024 sc1
    s_cmp_lg_u32 s61, 0
    s_cbranch_scc1 L_f1ok0
    s_waitcnt vmcnt(4)
    s_mov_b32 s79, 0
L_pc2:
    v_cmp_ne_u32 vcc, s60, v15
    s_cbranch_vccz L_pd2
    s_add_u32 s79, s79, 1
    s_cmp_gt_u32 s79, 100000
    s_cbranch_scc1 L_pd2
    s_sleep 4
    buffer_load_dword v15, v5, s[52:55], s89 offen offset:0 sc1
    s_waitcnt vmcnt(0)
    s_branch L_pc2
L_pd2:
L_f1ok0:
    s_waitcnt lgkmcnt(4)
    s_barrier
    ds_read_b64 v[176:177], v3 offset:32768
    s_add_u32 m0, s87, 512
    s_nop 0
    buffer_load_dwordx4 v8, s[52:55], s6 offen offset:0 sc1 lds
    buffer_load_dwordx4 v8, s[52:55], s6 offen offset:1024 sc1 lds
    buffer_load_dwordx4 v8, s[52:55], s6 offen offset:2048 sc1 lds
    buffer_load_dwordx4 v8, s[52:55], s6 offen offset:3072 sc1 lds
    s_waitcnt lgkmcnt(0)
    v_mfma_f32_32x32x16_bf16 v[96:111], v[176:179], v[180:183], v[96:111]
    v_xor_b32 v195, 64, v194
    ds_write2st64_b32 v195, v52, v236 offset0:4 offset1:20
    v_xor_b32 v195, 80, v194
    ds_write2st64_b32 v195, v53, v237 offset0:5 offset1:21
    v_mfma_f32_32x32x16_bf16 v[112:127], v[176:179], v[184:187], v[112:127]
    v_xor_b32 v195, 96, v194
    ds_write2st64_b32 v195, v54, v238 offset0:6 offset1:22
    v_xor_b32 v195, 112, v194
    ds_write2st64_b32 v195, v55, v239 offset0:7 offset1:23
    s_nop 2
    v_max_f32 v96, 0, v96
    v_max_f32 v97, 0, v97
    v_max_f32 v98, 0, v98
    v_max_f32 v99, 0, v99
    v_max_f32 v100, 0, v100
    v_max_f32 v101, 0, v101
    v_max_f32 v102, 0, v102
    v_max_f32 v103, 0, v103
    v_xor_b32 v195, 128, v194
    ds_write2st64_b32 v195, v56, v240 offset0:8 offset1:24
    v_xor_b32 v195, 144, v194
    ds_write2st64_b32 v195, v57, v241 offset0:9 offset1:25
    v_pk_mul_f32 v[96:97], v[96:97], v[96:97]
    v_pk_mul_f32 v[98:99], v[98:99], v[98:99]
    v_pk_mul_f32 v[100:101], v[100:101], v[100:101]
    v_pk_mul_f32 v[102:103], v[102:103], v[102:103]
    v_cvt_pk_bf16_f32 v144, v96, v97
    v_cvt_pk_bf16_f32 v145, v98, v99
    v_cvt_pk_bf16_f32 v146, v100, v101
    v_cvt_pk_bf16_f32 v147, v102, v103
    buffer_store_dwordx4 v[144:147], v8, s[52:55], s76 offen offset:0 sc1
    v_xor_b32 v195, 160, v194
    ds_write2st64_b32 v195, v58, v242 offset0:10 offset1:26
    v_xor_b32 v195, 176, v194
    ds_write2st64_b32 v195, v59, v243 offset0:11 offset1:27
    v_max_f32 v104, 0, v104
    v_max_f32 v105, 0, v105
    v_max_f32 v106, 0, v106
    v_max_f32 v107, 0, v107
    v_max_f32 v108, 0, v108
    v_max_f32 v109, 0, v109
    v_max_f32 v110, 0, v110
    v_max_f32 v111, 0, v111
    v_xor_b32 v195, 192, v194
    ds_write2st64_b32 v195, v60, v244 offset0:12 offset1:28
    v_xor_b32 v195, 208, v194
    ds_write2st64_b32 v195, v61, v245 offset0:13 offset1:29
    v_pk_mul_f32 v[104:105], v[104:105], v[104:105]
    v_pk_mul_f32 v[106:107], v[106:107], v[106:107]
    v_pk_mul_f32 v[108:109], v[108:109], v[108:109]
    v_pk_mul_f32 v[110:111], v[110:111], v[110:111]
    v_cvt_pk_bf16_f32 v148, v104, v105
    v_cvt_pk_bf16_f32 v149, v106, v107
    v_cvt_pk_bf16_f32 v150, v108, v109
    v_cvt_pk_bf16_f32 v151, v110, v111
    buffer_store_dwordx4 v[148:151], v8, s[52:55], s76 offen offset:1024 sc1
    v_xor_b32 v195, 224, v194
    ds_write2st64_b32 v195, v62, v246 offset0:14 offset1:30
    v_xor_b32 v195, 240, v194
    ds_write2st64_b32 v195, v63, v247 offset0:15 offset1:31
    v_max_f32 v112, 0, v112
    v_max_f32 v113, 0, v113
    v_max_f32 v114, 0, v114
    v_max_f32 v115, 0, v115
    v_max_f32 v116, 0, v116
    v_max_f32 v117, 0, v117
    v_max_f32 v118, 0, v118
    v_max_f32 v119, 0, v119
    ds_read_b128 a[192:195], v223
    ds_read_b128 a[196:199], v224
    ds_read_b128 a[200:203], v225
    ds_read_b128 a[204:207], v226
    ds_read_b128 a[208:211], v227
    v_pk_mul_f32 v[112:113], v[112:113], v[112:113]
    v_pk_mul_f32 v[114:115], v[114:115], v[114:115]
    v_pk_mul_f32 v[116:117], v[116:117], v[116:117]
    v_pk_mul_f32 v[118:119], v[118:119], v[118:119]
    v_cvt_pk_bf16_f32 v152, v112, v113
    v_cvt_pk_bf16_f32 v153, v114, v115
    v_cvt_pk_bf16_f32 v154, v116, v117
    v_cvt_pk_bf16_f32 v155, v118, v119
    buffer_store_dwordx4 v[152:155], v8, s[52:55], s77 offen offset:0 sc1
    ds_read_b128 a[212:215], v228
    ds_read_b128 a[216:219], v229
    ds_read_b128 a[220:223], v230
    ds_write2st64_b32 v194, v196, v209 offset0:0 offset1:16
    v_xor_b32 v195, 16, v194
    v_max_f32 v120, 0, v120
    v_max_f32 v121, 0, v121
    v_max_f32 v122, 0, v122
    v_max_f32 v123, 0, v123
    v_max_f32 v124, 0, v124
    v_max_f32 v125, 0, v125
    v_max_f32 v126, 0, v126
    v_max_f32 v127, 0, v127
    ds_write2st64_b32 v195, v197, v210 offset0:1 offset1:17
    v_xor_b32 v195, 32, v194
    ds_write2st64_b32 v195, v198, v211 offset0:2 offset1:18
    v_pk_mul_f32 v[120:121], v[120:121], v[120:121]
    v_pk_mul_f32 v[122:123], v[122:123], v[122:123]
    v_pk_mul_f32 v[124:125], v[124:125], v[124:125]
    v_pk_mul_f32 v[126:127], v[126:127], v[126:127]
    v_cvt_pk_bf16_f32 v156, v120, v121
    v_cvt_pk_bf16_f32 v157, v122, v123
    v_cvt_pk_bf16_f32 v158, v124, v125
    v_cvt_pk_bf16_f32 v159, v126, v127
    buffer_store_dwordx4 v[156:159], v8, s[52:55], s77 offen offset:1024 sc1
    v_xor_b32 v195, 64, v194
    ds_write2st64_b32 v195, v204, v212 offset0:4 offset1:20
    v_xor_b32 v195, 80, v194
    ds_write2st64_b32 v195, v204, v213 offset0:5 offset1:21
    v_xor_b32 v195, 96, v194
    ds_write2st64_b32 v195, v205, v214 offset0:6 offset1:22
    v_xor_b32 v195, 48, v194
    ds_write2st64_b32 v195, v199, v215 offset0:3 offset1:19
    v_xor_b32 v195, 128, v194
    ds_write2st64_b32 v195, v200, v216 offset0:8 offset1:24
    v_xor_b32 v195, 112, v194
    ds_write2st64_b32 v195, v206, v217 offset0:7 offset1:23
    v_xor_b32 v195, 192, v194
    ds_write2st64_b32 v195, v206, v218 offset0:12 offset1:28
    v_xor_b32 v195, 144, v194
    ds_write2st64_b32 v195, v201, v219 offset0:9 offset1:25
    v_xor_b32 v195, 160, v194
    ds_write2st64_b32 v195, v202, v220 offset0:10 offset1:26
    v_xor_b32 v195, 176, v194
    ds_write2st64_b32 v195, v203, v220 offset0:11 offset1:27
    v_xor_b32 v195, 208, v194
    ds_write2st64_b32 v195, v206, v221 offset0:13 offset1:29
    v_xor_b32 v195, 224, v194
    ds_write2st64_b32 v195, v207, v222 offset0:14 offset1:30
    v_xor_b32 v195, 240, v194
    ds_write2st64_b32 v195, v208, v222 offset0:15 offset1:31
    ds_read_b128 a[224:227], v223
    ds_read_b128 a[228:231], v224
    ds_read_b128 a[232:235], v225
    ds_read_b128 a[236:239], v226
    ds_read_b128 a[240:243], v227
    ds_read_b128 a[244:247], v228
    ds_read_b128 a[248:251], v229
    ds_read_b128 a[252:255], v230
    s_branch L_common
L_ln:
    s_lshl_b32 s64, s62, 2
    s_add_u32 s64, s64, s63
    s_sub_u32 s64, s64, 28
    s_lshl_b32 s68, s64, 16
    s_lshl_b32 s71, s61, 14
    s_add_u32 s68, s68, s71
    s_waitcnt lgkmcnt(0)
    s_mov_b64 s[40:41], s[4:5]
    s_add_u32 m0, s71, 0
    s_add_u32 s77, s68, 0
    buffer_load_dwordx4 v24, s[40:43], s77 offen offset:0 lds
    buffer_load_dwordx4 v25, s[40:43], s77 offen offset:1024 lds
    s_add_u32 m0, s71, 2048
    s_add_u32 s77, s68, 128
    buffer_load_dwordx4 v24, s[40:43], s77 offen offset:0 lds
    buffer_load_dwordx4 v25, s[40:43], s77 offen offset:1024 lds
    s_add_u32 m0, s71, 4096
    s_add_u32 s77, s68, 256
    buffer_load_dwordx4 v24, s[40:43], s77 offen offset:0 lds
    buffer_load_dwordx4 v25, s[40:43], s77 offen offset:1024 lds
    s_add_u32 m0, s71, 6144
    s_add_u32 s77, s68, 384
    buffer_load_dwordx4 v24, s[40:43], s77 offen offset:0 lds
    buffer_load_dwordx4 v25, s[40:43], s77 offen offset:1024 lds
    global_load_short_d16_hi v160, v2, s[6:7]
    global_load_short_d16_hi v161, v2, s[8:9]
    global_load_short_d16_hi v162, v2, s[10:11]
    global_load_short_d16_hi v163, v2, s[12:13]
    global_load_short_d16_hi v164, v2, s[14:15]
    global_load_short_d16_hi v165, v2, s[16:17]
    global_load_short_d16_hi v166, v3, s[18:19]
    s_load_dword s60, s[36:37], 0
    s_lshl_b32 s74, s67, 7
    s_lshl_b32 s75, s85, 6
    s_add_u32 s74, s74, s75
    s_load_dword s22, s[20:21], s74
    s_load_dword s23, s[30:31], s74
    s_add_u32 m0, s71, 8192
    s_add_u32 s77, s68, 512
    buffer_load_dwordx4 v24, s[40:43], s77 offen offset:0 lds
    buffer_load_dwordx4 v25, s[40:43], s77 offen offset:1024 lds
    s_add_u32 m0, s71, 10240
    s_add_u32 s77, s68, 640
    buffer_load_dwordx4 v24, s[40:43], s77 offen offset:0 lds
    buffer_load_dwordx4 v25, s[40:43], s77 offen offset:1024 lds
    s_add_u32 m0, s71, 12288
    s_add_u32 s77, s68, 768
    buffer_load_dwordx4 v24, s[40:43], s77 offen offset:0 lds
    buffer_load_dwordx4 v25, s[40:43], s77 offen offset:1024 lds
    s_add_u32 m0, s71, 14336
    s_add_u32 s77, s68, 896
    buffer_load_dwordx4 v24, s[40:43], s77 offen offset:0 lds
    buffer_load_dwordx4 v25, s[40:43], s77 offen offset:1024 lds
    s_mov_b64 s[44:45], s[24:25]
    s_mov_b64 s[48:49], s[28:29]
    s_mov_b64 s[52:53], s[36:37]
    s_mov_b64 s[56:57], s[32:33]
    v_lshlrev_b32 v28, 4, v1
    v_add_u32 v28, s71, v28
    v_bfe_u32 v3, v1, 2, 2
    v_lshrrev_b32 v7, 5, v1
    v_lshl_add_u32 v4, v7, 2, v3
    v_lshlrev_b32 v4, 7, v4
    v_lshrrev_b32 v3, 1, v3
    v_lshl_add_u32 v4, v3, 6, v4
    v_bfe_u32 v3, v1, 4, 1
    v_lshl_add_u32 v4, v3, 5, v4
    v_and_b32 v3, 3, v1
    v_lshl_add_u32 v4, v3, 3, v4
    v_add_u32 v32, s71, v4
    v_xor_b32 v33, 64, v32
    v_and_b32 v4, 31, v1
    v_lshlrev_b32 v4, 7, v4
    s_lshl_b32 s74, s61, 1
    v_add_u32 v5, s74, v7
    v_and_b32 v6, 7, v1
    v_xor_b32 v5, v5, v6
    v_lshl_add_u32 v4, v5, 4, v4
    v_add_u32 v36, 0x10000, v4
    s_add_u32 s75, s73, 131072
    v_bfe_u32 v4, v1, 2, 1
    v_lshrrev_b32 v2, 3, v1
    v_lshl_add_u32 v2, v4, 3, v2
    v_lshlrev_b32 v45, 3, v2
    v_lshlrev_b32 v37, 2, v2
    v_add_u32 v37, s75, v37
    v_lshlrev_b32 v38, 5, v7
    v_add_u32 v38, s75, v38
    v_lshl_add_u32 v3, v4, 3, v3
    v_bfe_u32 v4, v1, 3, 1
    v_lshl_add_u32 v3, v4, 2, v3
    v_lshlrev_b32 v29, 2, v3
    v_add_u32 v29, s75, v29
    v_mov_b32 v39, 0x3f803f80
    v_and_b32 v30, 1, v1
    v_lshlrev_b32 v30, 4, v30
    v_mov_b32 v16, 0
    v_mov_b32 v17, 0
    v_mov_b32 v18, 0
    v_mov_b32 v19, 0
    v_mov_b32 v20, 0
    v_mov_b32 v21, 0
    v_mov_b32 v22, 0
    v_mov_b32 v23, 0
    v_mov_b32 v40, 0
    v_mov_b32 v41, 0
    v_mov_b32 v34, 0
    v_mov_b32 v35, 0
    v_mov_b32 v56, 0
    v_mov_b32 v57, 0
    v_mov_b32 v58, 0
    v_mov_b32 v59, 0
    v_mov_b32 v60, 0
    v_mov_b32 v61, 0
    v_mov_b32 v62, 0
    v_mov_b32 v63, 0
    v_lshrrev_b32 v4, 3, v1
    v_and_b32 v5, 7, v1
    v_xor_b32 v6, v5, v4
    v_lshlrev_b32 v6, 4, v6
    v_lshl_add_u32 v6, v4, 7, v6
    s_mul_i32 s74, s61, 4096
    s_add_u32 s74, s74, 0x10000
    v_add_u32 v42, s74, v6
    v_mul_u32_u24 v43, 4224, v4
    v_lshl_add_u32 v43, v5, 4, v43
    v_mul_u32_u24 v44, 4224, v1
    s_mul_i32 s69, s61, 135168
    s_lshl_b32 s76, s64, 7
    s_add_u32 s69, s69, s76
    s_add_u32 s69, s69, 131200
    s_lshl_b32 s15, s64, 9
    s_lshl_b32 s74, s61, 7
    s_add_u32 s15, s15, s74
    s_add_u32 s15, s15, 16384
    s_lshl_b32 s68, s64, 2
    s_add_u32 s68, s68, 65536
    s_cmp_eq_u32 s61, 0
    s_cselect_b32 s68, s68, 16777216
    s_mov_b32 s8, 16777216
    s_mov_b32 s14, 16777216
    v_lshrrev_b32 v2, 5, v1
    v_mul_u32_u24 v2, 405504, v2
    v_add_u32 v44, v44, v2
    s_sub_u32 s75, s69, 16
    s_cmp_eq_u32 s64, 0
    s_cselect_b32 s75, s75, 16777216
    s_add_u32 s77, s75, 1081344
    buffer_store_dwordx4 v[56:59], v44, s[52:55], s75 offen sc1
    buffer_store_dwordx4 v[56:59], v44, s[52:55], s77 offen sc1
    s_waitcnt lgkmcnt(0)
    s_waitcnt vmcnt(23)
    ds_read_b128 v[128:131], v28 offset:0
    ds_read_b128 v[132:135], v28 offset:1024
    s_waitcnt vmcnt(21)
    ds_read_b128 v[136:139], v28 offset:2048
    ds_read_b128 v[140:143], v28 offset:3072
    s_waitcnt lgkmcnt(2)
    ds_read_b64_tr_b16 v[64:65], v32 offset:0
    ds_read_b64_tr_b16 v[66:67], v32 offset:1024
    ds_read_b64_tr_b16 v[68:69], v33 offset:0
    ds_read_b64_tr_b16 v[70:71], v33 offset:1024
    v_dot2c_f32_bf16 v40, v128, v39
    v_dot2c_f32_bf16 v41, v128, v128
    v_dot2c_f32_bf16 v34, v132, v39
    v_dot2c_f32_bf16 v35, v132, v132
    v_dot2c_f32_bf16 v40, v129, v39
    v_dot2c_f32_bf16 v41, v129, v129
    v_dot2c_f32_bf16 v34, v133, v39
    v_dot2c_f32_bf16 v35, v133, v133
    v_dot2c_f32_bf16 v40, v130, v39
    v_dot2c_f32_bf16 v41, v130, v130
    v_dot2c_f32_bf16 v34, v134, v39
    v_dot2c_f32_bf16 v35, v134, v134
    v_dot2c_f32_bf16 v40, v131, v39
    v_dot2c_f32_bf16 v41, v131, v131
    v_dot2c_f32_bf16 v34, v135, v39
    v_dot2c_f32_bf16 v35, v135, v135
    s_waitcnt vmcnt(19)
    ds_read_b128 v[144:147], v28 offset:4096
    ds_read_b128 v[148:151], v28 offset:5120
    s_waitcnt lgkmcnt(6)
    ds_read_b64_tr_b16 v[72:73], v32 offset:2048
    ds_read_b64_tr_b16 v[74:75], v32 offset:3072
    ds_read_b64_tr_b16 v[76:77], v33 offset:2048
    ds_read_b64_tr_b16 v[78:79], v33 offset:3072
    v_dot2c_f32_bf16 v40, v136, v39
    v_dot2c_f32_bf16 v41, v136, v136
    v_dot2c_f32_bf16 v34, v140, v39
    v_dot2c_f32_bf16 v35, v140, v140
    v_dot2c_f32_bf16 v40, v137, v39
    v_dot2c_f32_bf16 v41, v137, v137
    v_dot2c_f32_bf16 v34, v141, v39
    v_dot2c_f32_bf16 v35, v141, v141
    v_dot2c_f32_bf16 v40, v138, v39
    v_dot2c_f32_bf16 v41, v138, v138
    v_dot2c_f32_bf16 v34, v142, v39
    v_dot2c_f32_bf16 v35, v142, v142
    v_dot2c_f32_bf16 v40, v139, v39
    v_dot2c_f32_bf16 v41, v139, v139
    v_dot2c_f32_bf16 v34, v143, v39
    v_dot2c_f32_bf16 v35, v143, v143
    s_waitcnt vmcnt(17)
    ds_read_b128 v[152:155], v28 offset:6144
    ds_read_b128 v[156:159], v28 offset:7168
    s_waitcnt lgkmcnt(6)
    ds_read_b64_tr_b16 v[80:81], v32 offset:4096
    ds_read_b64_tr_b16 v[82:83], v32 offset:5120
    ds_read_b64_tr_b16 v[84:85], v33 offset:4096
    ds_read_b64_tr_b16 v[86:87], v33 offset:5120
    v_dot2c_f32_bf16 v40, v144, v39
    v_dot2c_f32_bf16 v41, v144, v144
    v_dot2c_f32_bf16 v34, v148, v39
    v_dot2c_f32_bf16 v35, v148, v148
    v_dot2c_f32_bf16 v40, v145, v39
    v_dot2c_f32_bf16 v41, v145, v145
    v_dot2c_f32_bf16 v34, v149, v39
    v_dot2c_f32_bf16 v35, v149, v149
    v_dot2c_f32_bf16 v40, v146, v39
    v_dot2c_f32_bf16 v41, v146, v146
    v_dot2c_f32_bf16 v34, v150, v39
    v_dot2c_f32_bf16 v35, v150, v150
    v_dot2c_f32_bf16 v40, v147, v39
    v_dot2c_f32_bf16 v41, v147, v147
    v_dot2c_f32_bf16 v34, v151, v39
    v_dot2c_f32_bf16 v35, v151, v151
    s_waitcnt vmcnt(8)
    ds_read_b128 v[128:131], v28 offset:8192
    ds_read_b128 v[132:135], v28 offset:9216
    s_waitcnt lgkmcnt(6)
    ds_read_b64_tr_b16 v[88:89], v32 offset:6144
    ds_read_b64_tr_b16 v[90:91], v32 offset:7168
    ds_read_b64_tr_b16 v[92:93], v33 offset:6144
    ds_read_b64_tr_b16 v[94:95], v33 offset:7168
    v_dot2c_f32_bf16 v40, v152, v39
    v_dot2c_f32_bf16 v41, v152, v152
    v_dot2c_f32_bf16 v34, v156, v39
    v_dot2c_f32_bf16 v35, v156, v156
    v_dot2c_f32_bf16 v40, v153, v39
    v_dot2c_f32_bf16 v41, v153, v153
    v_dot2c_f32_bf16 v34, v157, v39
    v_dot2c_f32_bf16 v35, v157, v157
    v_dot2c_f32_bf16 v40, v154, v39
    v_dot2c_f32_bf16 v41, v154, v154
    v_dot2c_f32_bf16 v34, v158, v39
    v_dot2c_f32_bf16 v35, v158, v158
    v_dot2c_f32_bf16 v40, v155, v39
    v_dot2c_f32_bf16 v41, v155, v155
    v_dot2c_f32_bf16 v34, v159, v39
    v_dot2c_f32_bf16 v35, v159, v159
    s_waitcnt vmcnt(6)
    ds_read_b128 v[136:139], v28 offset:10240
    ds_read_b128 v[140:143], v28 offset:11264
    s_waitcnt lgkmcnt(6)
    ds_read_b64_tr_b16 v[96:97], v32 offset:8192
    ds_read_b64_tr_b16 v[98:99], v32 offset:9216
    ds_read_b64_tr_b16 v[100:101], v33 offset:8192
    ds_read_b64_tr_b16 v[102:103], v33 offset:9216
    v_dot2c_f32_bf16 v40, v128, v39
    v_dot2c_f32_bf16 v41, v128, v128
    v_dot2c_f32_bf16 v34, v132, v39
    v_dot2c_f32_bf16 v35, v132, v132
    v_dot2c_f32_bf16 v40, v129, v39
    v_dot2c_f32_bf16 v41, v129, v129
    v_dot2c_f32_bf16 v34, v133, v39
    v_dot2c_f32_bf16 v35, v133, v133
    v_dot2c_f32_bf16 v40, v130, v39
    v_dot2c_f32_bf16 v41, v130, v130
    v_dot2c_f32_bf16 v34, v134, v39
    v_dot2c_f32_bf16 v35, v134, v134
    v_dot2c_f32_bf16 v40, v131, v39
    v_dot2c_f32_bf16 v41, v131, v131
    v_dot2c_f32_bf16 v34, v135, v39
    v_dot2c_f32_bf16 v35, v135, v135
    s_waitcnt vmcnt(4)
    ds_read_b128 v[144:147], v28 offset:12288
    ds_read_b128 v[148:151], v28 offset:13312
    s_waitcnt lgkmcnt(6)
    ds_read_b64_tr_b16 v[104:105], v32 offset:10240
    ds_read_b64_tr_b16 v[106:107], v32 offset:11264
    ds_read_b64_tr_b16 v[108:109], v33 offset:10240
    ds_read_b64_tr_b16 v[110:111], v33 offset:11264
    v_dot2c_f32_bf16 v40, v136, v39
    v_dot2c_f32_bf16 v41, v136, v136
    v_dot2c_f32_bf16 v34, v140, v39
    v_dot2c_f32_bf16 v35, v140, v140
    v_dot2c_f32_bf16 v40, v137, v39
    v_dot2c_f32_bf16 v41, v137, v137
    v_dot2c_f32_bf16 v34, v141, v39
    v_dot2c_f32_bf16 v35, v141, v141
    v_dot2c_f32_bf16 v40, v138, v39
    v_dot2c_f32_bf16 v41, v138, v138
    v_dot2c_f32_bf16 v34, v142, v39
    v_dot2c_f32_bf16 v35, v142, v142
    v_dot2c_f32_bf16 v40, v139, v39
    v_dot2c_f32_bf16 v41, v139, v139
    v_dot2c_f32_bf16 v34, v143, v39
    v_dot2c_f32_bf16 v35, v143, v143
    s_waitcnt vmcnt(2)
    ds_read_b128 v[152:155], v28 offset:14336
    ds_read_b128 v[156:159], v28 offset:15360
    s_waitcnt lgkmcnt(6)
    ds_read_b64_tr_b16 v[112:113], v32 offset:12288
    ds_read_b64_tr_b16 v[114:115], v32 offset:13312
    ds_read_b64_tr_b16 v[116:117], v33 offset:12288
    ds_read_b64_tr_b16 v[118:119], v33 offset:13312
    v_dot2c_f32_bf16 v40, v144, v39
    v_dot2c_f32_bf16 v41, v144, v144
    v_dot2c_f32_bf16 v34, v148, v39
    v_dot2c_f32_bf16 v35, v148, v148
    v_dot2c_f32_bf16 v40, v145, v39
    v_dot2c_f32_bf16 v41, v145, v145
    v_dot2c_f32_bf16 v34, v149, v39
    v_dot2c_f32_bf16 v35, v149, v149
    v_dot2c_f32_bf16 v40, v146, v39
    v_dot2c_f32_bf16 v41, v146, v146
    v_dot2c_f32_bf16 v34, v150, v39
    v_dot2c_f32_bf16 v35, v150, v150
    v_dot2c_f32_bf16 v40, v147, v39
    v_dot2c_f32_bf16 v41, v147, v147
    v_dot2c_f32_bf16 v34, v151, v39
    v_dot2c_f32_bf16 v35, v151, v151
    s_waitcnt lgkmcnt(4)
    ds_read_b64_tr_b16 v[120:121], v32 offset:14336
    ds_read_b64_tr_b16 v[122:123], v32 offset:15360
    ds_read_b64_tr_b16 v[124:125], v33 offset:14336
    ds_read_b64_tr_b16 v[126:127], v33 offset:15360
    v_dot2c_f32_bf16 v40, v152, v39
    v_dot2c_f32_bf16 v41, v152, v152
    v_dot2c_f32_bf16 v34, v156, v39
    v_dot2c_f32_bf16 v35, v156, v156
    v_dot2c_f32_bf16 v40, v153, v39
    v_dot2c_f32_bf16 v41, v153, v153
    v_dot2c_f32_bf16 v34, v157, v39
    v_dot2c_f32_bf16 v35, v157, v157
    v_dot2c_f32_bf16 v40, v154, v39
    v_dot2c_f32_bf16 v41, v154, v154
    v_dot2c_f32_bf16 v34, v158, v39
    v_dot2c_f32_bf16 v35, v158, v158
    v_dot2c_f32_bf16 v40, v155, v39
    v_dot2c_f32_bf16 v41, v155, v155
    v_dot2c_f32_bf16 v34, v159, v39
    v_dot2c_f32_bf16 v35, v159, v159
    v_add_f32_dpp v40, v40, v40 row_half_mirror row_mask:0xf bank_mask:0xf
    v_add_f32_dpp v41, v41, v41 row_half_mirror row_mask:0xf bank_mask:0xf
    v_add_f32_dpp v34, v34, v34 row_half_mirror row_mask:0xf bank_mask:0xf
    v_add_f32_dpp v35, v35, v35 row_half_mirror row_mask:0xf bank_mask:0xf
    s_mov_b32 s90, 0xf0f0f0f0
    s_mov_b32 s91, 0xf0f0f0f0
    v_cndmask_b32 v40, v40, v34, s[90:91]
    v_cndmask_b32 v41, v41, v35, s[90:91]
    s_nop 0
    v_add_f32_dpp v40, v40, v40 quad_perm:[1,0,3,2] row_mask:0xf bank_mask:0xf
    v_add_f32_dpp v41, v41, v41 quad_perm:[1,0,3,2] row_mask:0xf bank_mask:0xf
    s_nop 0
    v_add_f32_dpp v40, v40, v40 quad_perm:[2,3,0,1] row_mask:0xf bank_mask:0xf
    v_add_f32_dpp v41, v41, v41 quad_perm:[2,3,0,1] row_mask:0xf bank_mask:0xf
    v_mul_f32 v40, 0x3b000000, v40
    v_mul_f32 v41, 0x3b000000, v41
    v_fma_f32 v41, -v40, v40, v41
    v_max_f32 v41, 0, v41
    v_cvt_pk_bf16_f32 v41, v41, v41
    v_and_b32 v41, s78, v41
    v_add_f32 v41, 0x3727c5ac, v41
    v_cvt_pk_bf16_f32 v41, v41, v41
    v_and_b32 v41, s78, v41
    v_sqrt_f32 v41, v41
    s_nop 0
    v_cvt_pk_bf16_f32 v46, -v40, v41
    v_and_b32 v41, s78, v46
    v_lshlrev_b32 v40, 16, v46
    v_rcp_f32 v41, v41
    s_add_u32 s74, s60, 0x9e3779b9
    v_mov_b32 v47, s74
    v_mul_f32 v40, v40, v41
    ds_write2_b32 v37, v41, v40 offset0:0 offset1:16
    ds_read_b32 v31, v29
    ds_read_b128 v[48:51], v38 offset:64
    ds_read_b128 v[52:55], v38 offset:80
    s_mov_b32 exec_lo, 0x11111111
    s_mov_b32 exec_hi, 0x11111111
    buffer_store_dwordx2 v[46:47], v45, s[52:55], s15 offen sc1
    s_mov_b64 exec, -1
    s_waitcnt lgkmcnt(2)
    v_cvt_pk_bf16_f32 v2, v31, v31
    v_and_b32 v2, s78, v2
    v_sub_f32 v3, v31, v2
    v_cvt_pk_bf16_f32 v3, v3, v3
    v_lshrrev_b32 v2, 16, v2
    v_lshrrev_b32 v3, 16, v3
    v_lshlrev_b32 v2, v30, v2
    v_lshlrev_b32 v3, v30, v3
    s_mov_b32 exec_lo, 3
    s_mov_b32 exec_hi, 768
    v_mov_b32 v16, v2
    v_mov_b32 v20, v3
    s_mov_b32 exec_lo, 12
    s_mov_b32 exec_hi, 3072
    v_mov_b32 v17, v2
    v_mov_b32 v21, v3
    s_mov_b32 exec_lo, 48
    s_mov_b32 exec_hi, 12288
    v_mov_b32 v18, v2
    v_mov_b32 v22, v3
    s_mov_b32 exec_lo, 192
    s_mov_b32 exec_hi, 49152
    v_mov_b32 v19, v2
    v_mov_b32 v23, v3
    s_mov_b64 exec, -1
    s_waitcnt lgkmcnt(0)
    v_mfma_f32_32x32x16_bf16 v[128:143], v[16:19], v[64:67], v[48:63]
    v_mfma_f32_32x32x16_bf16 v[128:143], v[20:23], v[64:67], v[128:143]
    v_mfma_f32_32x32x16_bf16 v[144:159], v[16:19], v[68:71], v[48:63]
    v_mfma_f32_32x32x16_bf16 v[144:159], v[20:23], v[68:71], v[144:159]
    s_nop 9
    v_cvt_pk_bf16_f32 v212, v128, v129
    v_cvt_pk_bf16_f32 v213, v130, v131
    v_cvt_pk_bf16_f32 v214, v132, v133
    v_cvt_pk_bf16_f32 v215, v134, v135
    ds_write_b128 v36, v[212:215] offset:0
    v_mfma_f32_32x32x16_bf16 v[128:143], v[16:19], v[72:75], v[48:63]
    v_mfma_f32_32x32x16_bf16 v[128:143], v[20:23], v[72:75], v[128:143]
    v_cvt_pk_bf16_f32 v216, v144, v145
    v_cvt_pk_bf16_f32 v217, v146, v147
    v_cvt_pk_bf16_f32 v218, v148, v149
    v_cvt_pk_bf16_f32 v219, v150, v151
    ds_write_b128 v36, v[216:219] offset:4096
    v_mfma_f32_32x32x16_bf16 v[144:159], v[16:19], v[76:79], v[48:63]
    v_mfma_f32_32x32x16_bf16 v[144:159], v[20:23], v[76:79], v[144:159]
    s_nop 4
    v_cvt_pk_bf16_f32 v212, v128, v129
    v_cvt_pk_bf16_f32 v213, v130, v131
    v_cvt_pk_bf16_f32 v214, v132, v133
    v_cvt_pk_bf16_f32 v215, v134, v135
    ds_write_b128 v36, v[212:215] offset:8192
    v_mfma_f32_32x32x16_bf16 v[128:143], v[16:19], v[80:83], v[48:63]
    v_mfma_f32_32x32x16_bf16 v[128:143], v[20:23], v[80:83], v[128:143]
    v_cvt_pk_bf16_f32 v216, v144, v145
    v_cvt_pk_bf16_f32 v217, v146, v147
    v_cvt_pk_bf16_f32 v218, v148, v149
    v_cvt_pk_bf16_f32 v219, v150, v151
    ds_write_b128 v36, v[216:219] offset:12288
    v_mfma_f32_32x32x16_bf16 v[144:159], v[16:19], v[84:87], v[48:63]
    s_waitcnt lgkmcnt(0)
    s_barrier
    ds_read_b128 v[172:175], v42 offset:0
    ds_read_b128 v[176:179], v42 offset:1024
    ds_read_b128 v[180:183], v42 offset:2048
    ds_read_b128 v[184:187], v42 offset:3072
    v_mfma_f32_32x32x16_bf16 v[144:159], v[20:23], v[84:87], v[144:159]
    v_cvt_pk_bf16_f32 v212, v128, v129
    v_cvt_pk_bf16_f32 v213, v130, v131
    v_cvt_pk_bf16_f32 v214, v132, v133
    v_cvt_pk_bf16_f32 v215, v134, v135
    ds_write_b128 v36, v[212:215] offset:16384
    v_mfma_f32_32x32x16_bf16 v[128:143], v[16:19], v[88:91], v[48:63]
    s_add_u32 s86, s69, 0
    s_waitcnt lgkmcnt(4)
    buffer_store_dwordx4 v[172:175], v43, s[52:55], s86 offen sc1
    v_mfma_f32_32x32x16_bf16 v[128:143], v[20:23], v[88:91], v[128:143]
    s_nop 1
    v_cvt_pk_bf16_f32 v216, v144, v145
    v_cvt_pk_bf16_f32 v217, v146, v147
    v_cvt_pk_bf16_f32 v218, v148, v149
    v_cvt_pk_bf16_f32 v219, v150, v151
    ds_write_b128 v36, v[216:219] offset:20480
    v_mfma_f32_32x32x16_bf16 v[144:159], v[16:19], v[92:95], v[48:63]
    s_add_u32 s86, s69, 33792
    s_waitcnt lgkmcnt(4)
    buffer_store_dwordx4 v[176:179], v43, s[52:55], s86 offen sc1
    v_mfma_f32_32x32x16_bf16 v[144:159], v[20:23], v[92:95], v[144:159]
    v_cvt_pk_bf16_f32 v212, v128, v129
    v_cvt_pk_bf16_f32 v213, v130, v131
    v_cvt_pk_bf16_f32 v214, v132, v133
    v_cvt_pk_bf16_f32 v215, v134, v135
    ds_write_b128 v36, v[212:215] offset:24576
    v_mfma_f32_32x32x16_bf16 v[128:143], v[16:19], v[96:99], v[48:63]
    s_add_u32 s86, s69, 67584
    s_waitcnt lgkmcnt(4)
    buffer_store_dwordx4 v[180:183], v43, s[52:55], s86 offen sc1
    s_add_u32 s86, s69, 101376
    s_waitcnt lgkmcnt(3)
    buffer_store_dwordx4 v[184:187], v43, s[52:55], s86 offen sc1
    v_mfma_f32_32x32x16_bf16 v[128:143], v[20:23], v[96:99], v[128:143]
    v_cvt_pk_bf16_f32 v216, v144, v145
    v_cvt_pk_bf16_f32 v217, v146, v147
    v_cvt_pk_bf16_f32 v218, v148, v149
    v_cvt_pk_bf16_f32 v219, v150, v151
    ds_write_b128 v36, v[216:219] offset:28672
    v_mfma_f32_32x32x16_bf16 v[144:159], v[16:19], v[100:103], v[48:63]
    s_waitcnt lgkmcnt(0)
    s_barrier
    ds_read_b128 v[196:199], v42 offset:16384
    ds_read_b128 v[200:203], v42 offset:17408
    ds_read_b128 v[204:207], v42 offset:18432
    ds_read_b128 v[208:211], v42 offset:19456
    v_mfma_f32_32x32x16_bf16 v[144:159], v[20:23], v[100:103], v[144:159]
    v_cvt_pk_bf16_f32 v212, v128, v129
    v_cvt_pk_bf16_f32 v213, v130, v131
    v_cvt_pk_bf16_f32 v214, v132, v133
    v_cvt_pk_bf16_f32 v215, v134, v135
    ds_write_b128 v36, v[212:215] offset:32768
    v_mfma_f32_32x32x16_bf16 v[128:143], v[16:19], v[104:107], v[48:63]
    s_add_u32 s86, s69, 540672
    s_waitcnt lgkmcnt(4)
    buffer_store_dwordx4 v[196:199], v43, s[52:55], s86 offen sc1
    v_mfma_f32_32x32x16_bf16 v[128:143], v[20:23], v[104:107], v[128:143]
    s_nop 1
    v_cvt_pk_bf16_f32 v216, v144, v145
    v_cvt_pk_bf16_f32 v217, v146, v147
    v_cvt_pk_bf16_f32 v218, v148, v149
    v_cvt_pk_bf16_f32 v219, v150, v151
    ds_write_b128 v36, v[216:219] offset:36864
    v_mfma_f32_32x32x16_bf16 v[144:159], v[16:19], v[108:111], v[48:63]
    s_add_u32 s86, s69, 574464
    s_waitcnt lgkmcnt(4)
    buffer_store_dwordx4 v[200:203], v43, s[52:55], s86 offen sc1
    v_mfma_f32_32x32x16_bf16 v[144:159], v[20:23], v[108:111], v[144:159]
    v_cvt_pk_bf16_f32 v212, v128, v129
    v_cvt_pk_bf16_f32 v213, v130, v131
    v_cvt_pk_bf16_f32 v214, v132, v133
    v_cvt_pk_bf16_f32 v215, v134, v135
    ds_write_b128 v36, v[212:215] offset:40960
    v_mfma_f32_32x32x16_bf16 v[128:143], v[16:19], v[112:115], v[48:63]
    s_add_u32 s86, s69, 608256
    s_waitcnt lgkmcnt(4)
    buffer_store_dwordx4 v[204:207], v43, s[52:55], s86 offen sc1
    s_add_u32 s86, s69, 642048
    s_waitcnt lgkmcnt(3)
    buffer_store_dwordx4 v[208:211], v43, s[52:55], s86 offen sc1
    v_mfma_f32_32x32x16_bf16 v[128:143], v[20:23], v[112:115], v[128:143]
    v_cvt_pk_bf16_f32 v216, v144, v145
    v_cvt_pk_bf16_f32 v217, v146, v147
    v_cvt_pk_bf16_f32 v218, v148, v149
    v_cvt_pk_bf16_f32 v219, v150, v151
    ds_write_b128 v36, v[216:219] offset:45056
    v_mfma_f32_32x32x16_bf16 v[144:159], v[16:19], v[116:119], v[48:63]
    s_waitcnt lgkmcnt(0)
    s_barrier
    ds_read_b128 v[172:175], v42 offset:32768
    ds_read_b128 v[176:179], v42 offset:33792
    ds_read_b128 v[180:183], v42 offset:34816
    ds_read_b128 v[184:187], v42 offset:35840
    v_mfma_f32_32x32x16_bf16 v[144:159], v[20:23], v[116:119], v[144:159]
    v_cvt_pk_bf16_f32 v212, v128, v129
    v_cvt_pk_bf16_f32 v213, v130, v131
    v_cvt_pk_bf16_f32 v214, v132, v133
    v_cvt_pk_bf16_f32 v215, v134, v135
    ds_write_b128 v36, v[212:215] offset:49152
    v_mfma_f32_32x32x16_bf16 v[128:143], v[16:19], v[120:123], v[48:63]
    s_add_u32 s86, s69, 1081344
    s_waitcnt lgkmcnt(4)
    buffer_store_dwordx4 v[172:175], v43, s[52:55], s86 offen sc1
    v_mfma_f32_32x32x16_bf16 v[128:143], v[20:23], v[120:123], v[128:143]
    s_nop 1
    v_cvt_pk_bf16_f32 v216, v144, v145
    v_cvt_pk_bf16_f32 v217, v146, v147
    v_cvt_pk_bf16_f32 v218, v148, v149
    v_cvt_pk_bf16_f32 v219, v150, v151
    ds_write_b128 v36, v[216:219] offset:53248
    v_mfma_f32_32x32x16_bf16 v[144:159], v[16:19], v[124:127], v[48:63]
    s_add_u32 s86, s69, 1115136
    s_waitcnt lgkmcnt(4)
    buffer_store_dwordx4 v[176:179], v43, s[52:55], s86 offen sc1
    v_mfma_f32_32x32x16_bf16 v[144:159], v[20:23], v[124:127], v[144:159]
    v_cvt_pk_bf16_f32 v212, v128, v129
    v_cvt_pk_bf16_f32 v213, v130, v131
    v_cvt_pk_bf16_f32 v214, v132, v133
    v_cvt_pk_bf16_f32 v215, v134, v135
    ds_write_b128 v36, v[212:215] offset:57344
    s_add_u32 s86, s69, 1148928
    s_waitcnt lgkmcnt(4)
    buffer_store_dwordx4 v[180:183], v43, s[52:55], s86 offen sc1
    s_add_u32 s86, s69, 1182720
    s_waitcnt lgkmcnt(3)
    buffer_store_dwordx4 v[184:187], v43, s[52:55], s86 offen sc1
    s_nop 0
    v_cvt_pk_bf16_f32 v216, v144, v145
    v_cvt_pk_bf16_f32 v217, v146, v147
    v_cvt_pk_bf16_f32 v218, v148, v149
    v_cvt_pk_bf16_f32 v219, v150, v151
    ds_write_b128 v36, v[216:219] offset:61440
    s_waitcnt lgkmcnt(0)
    s_barrier
    ds_read_b128 v[196:199], v42 offset:49152
    ds_read_b128 v[200:203], v42 offset:50176
    ds_read_b128 v[204:207], v42 offset:51200
    ds_read_b128 v[208:211], v42 offset:52224
    s_add_u32 s86, s69, 1622016
    s_waitcnt lgkmcnt(3)
    buffer_store_dwordx4 v[196:199], v43, s[52:55], s86 offen sc1
    s_add_u32 s86, s69, 1655808
    s_waitcnt lgkmcnt(2)
    buffer_store_dwordx4 v[200:203], v43, s[52:55], s86 offen sc1
    s_add_u32 s86, s69, 1689600
    s_waitcnt lgkmcnt(1)
    buffer_store_dwordx4 v[204:207], v43, s[52:55], s86 offen sc1
    s_add_u32 s86, s69, 1723392
    s_waitcnt lgkmcnt(0)
    buffer_store_dwordx4 v[208:211], v43, s[52:55], s86 offen sc1
    s_mul_i32 s87, s85, 9280
    s_mul_i32 s74, s84, 4640
    s_add_u32 s87, s87, s74
    s_add_u32 s87, s87, 98304
    s_mul_i32 s88, s61, 4224
    s_lshl_b32 s74, s84, 2
    s_sub_u32 s88, s88, s74
    s_add_u32 s88, s88, 117876
    s_and_b32 s89, s2, 7
    s_lshl_b32 s89, s89, 9
    s_add_u32 s89, s89, 65536
    s_lshl_b32 s74, s61, 24
    s_add_u32 s89, s89, s74
    s_lshl_b32 s74, s2, 1
    s_add_u32 s74, s74, s85
    s_mul_i32 s74, s74, 4224
    s_lshl_b32 s75, s84, 1
    s_add_u32 s74, s74, s75
    s_add_u32 s6, s74, 131198
    s_add_u32 s18, s73, 131072
    s_mov_b32 s92, 0xaaaaaaaa
    s_mov_b32 s93, 0xaaaaaaaa
    v_lshlrev_b32 v8, 4, v1
    v_bfe_u32 v3, v1, 2, 2
    v_lshrrev_b32 v4, 5, v1
    v_lshl_add_u32 v4, v4, 2, v3
    v_lshlrev_b32 v4, 7, v4
    v_lshrrev_b32 v3, 1, v3
    v_xor_b32 v3, s85, v3
    v_lshl_add_u32 v4, v3, 6, v4
    v_bfe_u32 v3, v1, 4, 1
    v_lshl_add_u32 v4, v3, 5, v4
    v_and_b32 v3, 3, v1
    v_lshl_add_u32 v4, v3, 3, v4
    v_add_u32 v11, s73, v4
    v_xor_b32 v12, 64, v11
    v_add_u32 v13, 0x10000, v11
    v_add_u32 v14, 0x10000, v12
    v_and_b32 v3, 1, v1
    v_and_b32 v2, 15, v1
    v_and_b32 v4, 0x30, v1
    v_mul_u32_u24 v5, 4220, v3
    v_add_u32 v5, v5, v4
    v_lshlrev_b32 v6, 2, v2
    v_sub_u32 v5, v5, v6
    s_mul_i32 s74, s85, 8448
    s_lshl_b32 s75, s84, 8
    s_sub_u32 s74, s74, s75
    s_add_u32 s74, s74, 117184
    v_add_u32 v9, s74, v5
    v_mul_u32_u24 v5, 4640, v3
    v_add_u32 v5, v5, v4
    v_lshrrev_b32 v6, 1, v2
    v_lshl_add_u32 v5, v6, 6, v5
    s_mul_i32 s74, s85, 9280
    s_sub_u32 s74, s74, s75
    s_add_u32 s74, s74, 98624
    v_add_u32 v10, s74, v5
    v_lshlrev_b32 v7, 12, v4
    v_lshl_add_u32 v7, v2, 4, v7
    s_lshl_b32 s74, s61, 19
    s_lshl_b32 s75, s2, 8
    s_add_u32 s74, s74, s75
    s_add_u32 s12, s74, 3145728
    s_add_u32 s13, s12, 262144
    s_lshl_b32 s74, s61, 7
    s_lshl_b32 s7, s66, 9
    s_add_u32 s7, s7, s74
    s_add_u32 s7, s7, 32768
    v_min_u32 v6, 6, v1
    v_lshlrev_b32 v6, 2, v6
    v_and_b32 v2, 31, v1
    v_lshlrev_b32 v5, 2, v2
    s_lshl_b32 s74, s66, 1
    s_add_u32 s82, s74, s84
    s_xor_b32 s76, s82, 1
    s_mul_i32 s77, s61, 28672
    s_add_u32 s77, s77, 6291456
    s_mul_i32 s80, s82, 114688
    s_add_u32 s80, s80, s77
    s_mul_i32 s81, s76, 114688
    s_add_u32 s81, s81, s77
    s_lshl_b32 s16, s82, 8
    s_add_u32 s16, s16, 16384
    s_lshl_b32 s74, s67, 7
    s_lshl_b32 s75, s85, 6
    s_add_u32 s74, s74, s75
    s_mov_b32 s19, s74
    s_lshl_b32 s83, s82, 15
    s_add_u32 s83, s83, s74
    s_lshl_b32 s9, s66, 16
    s_lshl_b32 s74, s74, 6
    s_add_u32 s9, s9, s74
    s_lshl_b32 s74, s84, 7
    s_add_u32 s9, s9, s74
    s_add_u32 s9, s9, 3145728
    s_lshl_b32 s10, s61, 11
    s_and_b32 s74, s2, 0xf0
    s_add_u32 s74, s74, s2
    s_lshl_b32 s74, s74, 2
    s_add_u32 s10, s10, s74
    s_add_u32 s10, s10, 4096
    s_lshr_b32 s11, s66, 3
    s_lshl_b32 s11, s11, 11
    s_lshl_b32 s74, s19, 1
    s_add_u32 s11, s11, s74
    s_add_u32 s11, s11, 4096
    v_lshlrev_b32 v194, 2, v1
    v_add_u32 v194, s18, v194
    v_and_b32 v2, 31, v1
    v_and_b32 v3, 15, v1
    v_lshrrev_b32 v4, 5, v1
    v_xor_b32 v3, v3, v4
    v_lshlrev_b32 v3, 4, v3
    v_lshl_add_u32 v2, v2, 8, v3
    v_add_u32 v223, s18, v2
    v_xor_b32 v224, 32, v223
    v_xor_b32 v225, 64, v223
    v_xor_b32 v226, 96, v223
    v_xor_b32 v227, 128, v223
    v_xor_b32 v228, 160, v223
    v_xor_b32 v229, 192, v223
    v_xor_b32 v230, 224, v223
    s_waitcnt lgkmcnt(0)
    s_add_u32 s60, s60, 0x9e3779b9
    s_mov_b32 s17, 0x3fb8aa3b
    v_mul_f32 v167, s17, v166
    v_fma_f32 v168, s17, v166, -v167
    v_fmac_f32 v168, 0x32a57060, v166
    v_exp_f32 v167, v167
    v_mul_f32 v168, 0x3f317218, v168
    v_fma_f32 v167, v167, v168, v167
    v_cvt_pk_bf16_f32 v167, v167, v167
    v_and_b32 v166, s78, v167
    v_mul_f32 v160, v166, v160
    v_mul_f32 v161, v166, v161
    v_mul_f32 v162, v166, v162
    v_mul_f32 v163, v166, v163
    v_mul_f32 v160, s17, v160
    v_mul_f32 v161, 0.15915494, v161
    s_waitcnt vmcnt(0)
    s_barrier
    v_mov_b32 v2, s60
    v_lshlrev_b32 v3, 9, v1
    s_mov_b64 exec, 255
    buffer_store_dword v2, v3, s[52:55], s68 offen sc1
    s_mov_b64 exec, -1
    v_mul_f32 v167, 0x41000000, v160
    s_add_u32 m0, s73, 0
    s_add_u32 s86, s70, 0
    buffer_load_dwordx4 v24, s[48:51], s86 offen offset:0 lds
    v_mul_f32 v168, 0x41000000, v161
    v_exp_f32 v167, v167
    v_fract_f32 v168, v168
    v_cos_f32 v169, v168
    v_sin_f32 v170, v168
    v_mul_f32 v178, v167, v169
    v_mul_f32 v179, v167, v170
    v_mul_f32 v167, 0x43000000, v160
    v_mul_f32 v168, 0x43000000, v161
    v_exp_f32 v167, v167
    buffer_load_dwordx4 v25, s[48:51], s86 offen offset:1024 lds
    v_fract_f32 v168, v168
    v_cos_f32 v169, v168
    v_sin_f32 v170, v168
    v_mul_f32 v190, v167, v169
    v_mul_f32 v191, v167, v170
    v_mov_b32 v48, 0x3f80
    v_cvt_pk_bf16_f32 v232, v190, v191
    v_pk_mul_f32 v[192:193], v[190:191], v[178:179] op_sel:[0,0] op_sel_hi:[0,1]
    v_pk_fma_f32 v[188:189], v[190:191], v[178:179], v[192:193] op_sel:[1,1,0] op_sel_hi:[1,0,1] neg_lo:[0,1,0]
    v_cvt_pk_bf16_f32 v49, v178, v179
    buffer_load_dwordx4 v26, s[48:51], s86 offen offset:2048 lds
    v_cvt_pk_bf16_f32 v233, v188, v189
    v_pk_mul_f32 v[192:193], v[178:179], v[178:179] op_sel:[0,0] op_sel_hi:[0,1]
    v_pk_fma_f32 v[184:185], v[178:179], v[178:179], v[192:193] op_sel:[1,1,0] op_sel_hi:[1,0,1] neg_lo:[0,1,0]
    v_pk_mul_f32 v[192:193], v[188:189], v[178:179] op_sel:[0,0] op_sel_hi:[0,1]
    v_pk_fma_f32 v[190:191], v[188:189], v[178:179], v[192:193] op_sel:[1,1,0] op_sel_hi:[1,0,1] neg_lo:[0,1,0]
    v_cvt_pk_bf16_f32 v50, v184, v185
    v_cvt_pk_bf16_f32 v234, v190, v191
    v_pk_mul_f32 v[192:193], v[184:185], v[178:179] op_sel:[0,0] op_sel_hi:[0,1]
    v_pk_fma_f32 v[186:187], v[184:185], v[178:179], v[192:193] op_sel:[1,1,0] op_sel_hi:[1,0,1] neg_lo:[0,1,0]
    v_pk_mul_f32 v[192:193], v[190:191], v[178:179] op_sel:[0,0] op_sel_hi:[0,1]
    buffer_load_dwordx4 v27, s[48:51], s86 offen offset:3072 lds
    v_pk_fma_f32 v[188:189], v[190:191], v[178:179], v[192:193] op_sel:[1,1,0] op_sel_hi:[1,0,1] neg_lo:[0,1,0]
    v_cvt_pk_bf16_f32 v51, v186, v187
    v_cvt_pk_bf16_f32 v235, v188, v189
    v_pk_mul_f32 v[192:193], v[186:187], v[178:179] op_sel:[0,0] op_sel_hi:[0,1]
    v_pk_fma_f32 v[184:185], v[186:187], v[178:179], v[192:193] op_sel:[1,1,0] op_sel_hi:[1,0,1] neg_lo:[0,1,0]
    v_pk_mul_f32 v[192:193], v[188:189], v[178:179] op_sel:[0,0] op_sel_hi:[0,1]
    v_pk_fma_f32 v[190:191], v[188:189], v[178:179], v[192:193] op_sel:[1,1,0] op_sel_hi:[1,0,1] neg_lo:[0,1,0]
    v_cvt_pk_bf16_f32 v52, v184, v185
    v_cvt_pk_bf16_f32 v236, v190, v191
    v_pk_mul_f32 v[192:193], v[184:185], v[178:179] op_sel:[0,0] op_sel_hi:[0,1]
    s_add_u32 m0, s73, 4096
    s_add_u32 s86, s70, 32768
    buffer_load_dwordx4 v24, s[48:51], s86 offen offset:0 lds
    v_pk_fma_f32 v[186:187], v[184:185], v[178:179], v[192:193] op_sel:[1,1,0] op_sel_hi:[1,0,1] neg_lo:[0,1,0]
    v_pk_mul_f32 v[192:193], v[190:191], v[178:179] op_sel:[0,0] op_sel_hi:[0,1]
    v_pk_fma_f32 v[188:189], v[190:191], v[178:179], v[192:193] op_sel:[1,1,0] op_sel_hi:[1,0,1] neg_lo:[0,1,0]
    v_cvt_pk_bf16_f32 v53, v186, v187
    v_cvt_pk_bf16_f32 v237, v188, v189
    v_pk_mul_f32 v[192:193], v[186:187], v[178:179] op_sel:[0,0] op_sel_hi:[0,1]
    v_pk_fma_f32 v[184:185], v[186:187], v[178:179], v[192:193] op_sel:[1,1,0] op_sel_hi:[1,0,1] neg_lo:[0,1,0]
    v_pk_mul_f32 v[192:193], v[188:189], v[178:179] op_sel:[0,0] op_sel_hi:[0,1]
    v_pk_fma_f32 v[190:191], v[188:189], v[178:179], v[192:193] op_sel:[1,1,0] op_sel_hi:[1,0,1] neg_lo:[0,1,0]
    v_cvt_pk_bf16_f32 v54, v184, v185
    buffer_load_dwordx4 v25, s[48:51], s86 offen offset:1024 lds
    v_cvt_pk_bf16_f32 v238, v190, v191
    v_pk_mul_f32 v[192:193], v[184:185], v[178:179] op_sel:[0,0] op_sel_hi:[0,1]
    v_pk_fma_f32 v[186:187], v[184:185], v[178:179], v[192:193] op_sel:[1,1,0] op_sel_hi:[1,0,1] neg_lo:[0,1,0]
    v_pk_mul_f32 v[192:193], v[190:191], v[178:179] op_sel:[0,0] op_sel_hi:[0,1]
    v_pk_fma_f32 v[188:189], v[190:191], v[178:179], v[192:193] op_sel:[1,1,0] op_sel_hi:[1,0,1] neg_lo:[0,1,0]
    v_cvt_pk_bf16_f32 v55, v186, v187
    v_cvt_pk_bf16_f32 v239, v188, v189
    v_pk_mul_f32 v[192:193], v[186:187], v[178:179] op_sel:[0,0] op_sel_hi:[0,1]
    v_pk_fma_f32 v[184:185], v[186:187], v[178:179], v[192:193] op_sel:[1,1,0] op_sel_hi:[1,0,1] neg_lo:[0,1,0]
    v_pk_mul_f32 v[192:193], v[188:189], v[178:179] op_sel:[0,0] op_sel_hi:[0,1]
    buffer_load_dwordx4 v26, s[48:51], s86 offen offset:2048 lds
    v_pk_fma_f32 v[190:191], v[188:189], v[178:179], v[192:193] op_sel:[1,1,0] op_sel_hi:[1,0,1] neg_lo:[0,1,0]
    v_cvt_pk_bf16_f32 v56, v184, v185
    v_cvt_pk_bf16_f32 v240, v190, v191
    v_pk_mul_f32 v[192:193], v[184:185], v[178:179] op_sel:[0,0] op_sel_hi:[0,1]
    v_pk_fma_f32 v[186:187], v[184:185], v[178:179], v[192:193] op_sel:[1,1,0] op_sel_hi:[1,0,1] neg_lo:[0,1,0]
    v_pk_mul_f32 v[192:193], v[190:191], v[178:179] op_sel:[0,0] op_sel_hi:[0,1]
    v_pk_fma_f32 v[188:189], v[190:191], v[178:179], v[192:193] op_sel:[1,1,0] op_sel_hi:[1,0,1] neg_lo:[0,1,0]
    v_cvt_pk_bf16_f32 v57, v186, v187
    v_cvt_pk_bf16_f32 v241, v188, v189
    v_pk_mul_f32 v[192:193], v[186:187], v[178:179] op_sel:[0,0] op_sel_hi:[0,1]
    buffer_load_dwordx4 v27, s[48:51], s86 offen offset:3072 lds
    v_pk_fma_f32 v[184:185], v[186:187], v[178:179], v[192:193] op_sel:[1,1,0] op_sel_hi:[1,0,1] neg_lo:[0,1,0]
    v_pk_mul_f32 v[192:193], v[188:189], v[178:179] op_sel:[0,0] op_sel_hi:[0,1]
    v_pk_fma_f32 v[190:191], v[188:189], v[178:179], v[192:193] op_sel:[1,1,0] op_sel_hi:[1,0,1] neg_lo:[0,1,0]
    v_cvt_pk_bf16_f32 v58, v184, v185
    v_cvt_pk_bf16_f32 v242, v190, v191
    v_pk_mul_f32 v[192:193], v[184:185], v[178:179] op_sel:[0,0] op_sel_hi:[0,1]
    v_pk_fma_f32 v[186:187], v[184:185], v[178:179], v[192:193] op_sel:[1,1,0] op_sel_hi:[1,0,1] neg_lo:[0,1,0]
    v_pk_mul_f32 v[192:193], v[190:191], v[178:179] op_sel:[0,0] op_sel_hi:[0,1]
    v_pk_fma_f32 v[188:189], v[190:191], v[178:179], v[192:193] op_sel:[1,1,0] op_sel_hi:[1,0,1] neg_lo:[0,1,0]
    v_cvt_pk_bf16_f32 v59, v186, v187
    s_add_u32 m0, s73, 32768
    s_add_u32 s86, s70, 65536
    buffer_load_dwordx4 v24, s[48:51], s86 offen offset:0 lds
    v_cvt_pk_bf16_f32 v243, v188, v189
    v_pk_mul_f32 v[192:193], v[186:187], v[178:179] op_sel:[0,0] op_sel_hi:[0,1]
    v_pk_fma_f32 v[184:185], v[186:187], v[178:179], v[192:193] op_sel:[1,1,0] op_sel_hi:[1,0,1] neg_lo:[0,1,0]
    v_pk_mul_f32 v[192:193], v[188:189], v[178:179] op_sel:[0,0] op_sel_hi:[0,1]
    v_pk_fma_f32 v[190:191], v[188:189], v[178:179], v[192:193] op_sel:[1,1,0] op_sel_hi:[1,0,1] neg_lo:[0,1,0]
    v_cvt_pk_bf16_f32 v60, v184, v185
    v_cvt_pk_bf16_f32 v244, v190, v191
    v_pk_mul_f32 v[192:193], v[184:185], v[178:179] op_sel:[0,0] op_sel_hi:[0,1]
    v_pk_fma_f32 v[186:187], v[184:185], v[178:179], v[192:193] op_sel:[1,1,0] op_sel_hi:[1,0,1] neg_lo:[0,1,0]
    v_pk_mul_f32 v[192:193], v[190:191], v[178:179] op_sel:[0,0] op_sel_hi:[0,1]
    buffer_load_dwordx4 v25, s[48:51], s86 offen offset:1024 lds
    v_pk_fma_f32 v[188:189], v[190:191], v[178:179], v[192:193] op_sel:[1,1,0] op_sel_hi:[1,0,1] neg_lo:[0,1,0]
    v_cvt_pk_bf16_f32 v61, v186, v187
    v_cvt_pk_bf16_f32 v245, v188, v189
    v_pk_mul_f32 v[192:193], v[186:187], v[178:179] op_sel:[0,0] op_sel_hi:[0,1]
    v_pk_fma_f32 v[184:185], v[186:187], v[178:179], v[192:193] op_sel:[1,1,0] op_sel_hi:[1,0,1] neg_lo:[0,1,0]
    v_pk_mul_f32 v[192:193], v[188:189], v[178:179] op_sel:[0,0] op_sel_hi:[0,1]
    v_pk_fma_f32 v[190:191], v[188:189], v[178:179], v[192:193] op_sel:[1,1,0] op_sel_hi:[1,0,1] neg_lo:[0,1,0]
    v_cvt_pk_bf16_f32 v62, v184, v185
    v_cvt_pk_bf16_f32 v246, v190, v191
    v_pk_mul_f32 v[192:193], v[184:185], v[178:179] op_sel:[0,0] op_sel_hi:[0,1]
    buffer_load_dwordx4 v26, s[48:51], s86 offen offset:2048 lds
    v_pk_fma_f32 v[186:187], v[184:185], v[178:179], v[192:193] op_sel:[1,1,0] op_sel_hi:[1,0,1] neg_lo:[0,1,0]
    v_pk_mul_f32 v[192:193], v[190:191], v[178:179] op_sel:[0,0] op_sel_hi:[0,1]
    v_pk_fma_f32 v[188:189], v[190:191], v[178:179], v[192:193] op_sel:[1,1,0] op_sel_hi:[1,0,1] neg_lo:[0,1,0]
    v_cvt_pk_bf16_f32 v63, v186, v187
    v_cvt_pk_bf16_f32 v247, v188, v189
    v_exp_f32 v167, v160
    v_fract_f32 v168, v161
    v_cos_f32 v169, v168
    v_sin_f32 v170, v168
    v_mul_f32 v172, v167, v169
    buffer_load_dwordx4 v27, s[48:51], s86 offen offset:3072 lds
    v_mul_f32 v173, v167, v170
    v_mul_f32 v167, 0x43800000, v160
    v_mul_f32 v168, 0x43800000, v161
    v_exp_f32 v167, v167
    v_fract_f32 v168, v168
    v_cos_f32 v169, v168
    v_sin_f32 v170, v168
    v_mul_f32 v180, v167, v169
    v_mul_f32 v181, v167, v170
    v_pk_mul_f32 v[192:193], v[164:165], v[162:163] op_sel:[0,0] op_sel_hi:[0,1]
    s_add_u32 m0, s73, 36864
    s_add_u32 s86, s70, 98304
    buffer_load_dwordx4 v24, s[48:51], s86 offen offset:0 lds
    v_pk_fma_f32 v[182:183], v[164:165], v[162:163], v[192:193] op_sel:[1,1,0] op_sel_hi:[1,0,1] neg_lo:[0,1,0]
    v_pk_mul_f32 v[192:193], v[172:173], v[172:173] op_sel:[0,0] op_sel_hi:[0,1]
    v_pk_fma_f32 v[174:175], v[172:173], v[172:173], v[192:193] op_sel:[1,1,0] op_sel_hi:[1,0,1] neg_lo:[0,1,0]
    v_pk_mul_f32 v[192:193], v[174:175], v[174:175] op_sel:[0,0] op_sel_hi:[0,1]
    v_pk_fma_f32 v[176:177], v[174:175], v[174:175], v[192:193] op_sel:[1,1,0] op_sel_hi:[1,0,1] neg_lo:[0,1,0]
    v_cvt_pk_bf16_f32 v196, v182, -v183
    v_pk_mul_f32 v[192:193], v[182:183], v[172:173] op_sel:[0,0] op_sel_hi:[0,1]
    v_pk_fma_f32 v[184:185], v[182:183], v[172:173], v[192:193] op_sel:[1,1,0] op_sel_hi:[1,0,1] neg_lo:[0,1,0]
    v_cvt_pk_bf16_f32 v197, v184, -v185
    v_pk_mul_f32 v[192:193], v[184:185], v[172:173] op_sel:[0,0] op_sel_hi:[0,1]
    buffer_load_dwordx4 v25, s[48:51], s86 offen offset:1024 lds
    v_pk_fma_f32 v[186:187], v[184:185], v[172:173], v[192:193] op_sel:[1,1,0] op_sel_hi:[1,0,1] neg_lo:[0,1,0]
    v_cvt_pk_bf16_f32 v198, v186, -v187
    v_pk_mul_f32 v[192:193], v[186:187], v[172:173] op_sel:[0,0] op_sel_hi:[0,1]
    v_pk_fma_f32 v[184:185], v[186:187], v[172:173], v[192:193] op_sel:[1,1,0] op_sel_hi:[1,0,1] neg_lo:[0,1,0]
    v_cvt_pk_bf16_f32 v199, v184, -v185
    v_pk_mul_f32 v[192:193], v[184:185], v[172:173] op_sel:[0,0] op_sel_hi:[0,1]
    v_pk_fma_f32 v[186:187], v[184:185], v[172:173], v[192:193] op_sel:[1,1,0] op_sel_hi:[1,0,1] neg_lo:[0,1,0]
    v_cvt_pk_bf16_f32 v200, v186, -v187
    v_pk_mul_f32 v[192:193], v[186:187], v[172:173] op_sel:[0,0] op_sel_hi:[0,1]
    v_pk_fma_f32 v[184:185], v[186:187], v[172:173], v[192:193] op_sel:[1,1,0] op_sel_hi:[1,0,1] neg_lo:[0,1,0]
    buffer_load_dwordx4 v26, s[48:51], s86 offen offset:2048 lds
    v_cvt_pk_bf16_f32 v201, v184, -v185
    v_pk_mul_f32 v[192:193], v[184:185], v[172:173] op_sel:[0,0] op_sel_hi:[0,1]
    v_pk_fma_f32 v[186:187], v[184:185], v[172:173], v[192:193] op_sel:[1,1,0] op_sel_hi:[1,0,1] neg_lo:[0,1,0]
    v_cvt_pk_bf16_f32 v202, v186, -v187
    v_pk_mul_f32 v[192:193], v[186:187], v[172:173] op_sel:[0,0] op_sel_hi:[0,1]
    v_pk_fma_f32 v[184:185], v[186:187], v[172:173], v[192:193] op_sel:[1,1,0] op_sel_hi:[1,0,1] neg_lo:[0,1,0]
    v_cvt_pk_bf16_f32 v203, v184, -v185
    v_pk_mul_f32 v[192:193], v[182:183], v[180:181] op_sel:[0,0] op_sel_hi:[0,1]
    v_pk_fma_f32 v[188:189], v[182:183], v[180:181], v[192:193] op_sel:[1,1,0] op_sel_hi:[1,0,1] neg_lo:[0,1,0]
    v_cvt_pk_bf16_f32 v204, v188, -v189
    buffer_load_dwordx4 v27, s[48:51], s86 offen offset:3072 lds
    v_pk_mul_f32 v[192:193], v[188:189], v[174:175] op_sel:[0,0] op_sel_hi:[0,1]
    v_pk_fma_f32 v[184:185], v[188:189], v[174:175], v[192:193] op_sel:[1,1,0] op_sel_hi:[1,0,1] neg_lo:[0,1,0]
    v_cvt_pk_bf16_f32 v205, v184, -v185
    v_pk_mul_f32 v[192:193], v[184:185], v[174:175] op_sel:[0,0] op_sel_hi:[0,1]
    v_pk_fma_f32 v[186:187], v[184:185], v[174:175], v[192:193] op_sel:[1,1,0] op_sel_hi:[1,0,1] neg_lo:[0,1,0]
    v_cvt_pk_bf16_f32 v206, v186, -v187
    v_pk_mul_f32 v[192:193], v[186:187], v[174:175] op_sel:[0,0] op_sel_hi:[0,1]
    v_pk_fma_f32 v[184:185], v[186:187], v[174:175], v[192:193] op_sel:[1,1,0] op_sel_hi:[1,0,1] neg_lo:[0,1,0]
    v_cvt_pk_bf16_f32 v207, v184, -v185
    v_pk_mul_f32 v[192:193], v[184:185], v[174:175] op_sel:[0,0] op_sel_hi:[0,1]
    s_add_u32 m0, s73, 65536
    s_add_u32 s86, s70, 131072
    buffer_load_dwordx4 v24, s[48:51], s86 offen offset:0 lds
    v_pk_fma_f32 v[186:187], v[184:185], v[174:175], v[192:193] op_sel:[1,1,0] op_sel_hi:[1,0,1] neg_lo:[0,1,0]
    v_cvt_pk_bf16_f32 v208, v186, -v187
    v_pk_mul_f32 v[192:193], v[188:189], v[180:181] op_sel:[0,0] op_sel_hi:[0,1]
    v_pk_fma_f32 v[190:191], v[188:189], v[180:181], v[192:193] op_sel:[1,1,0] op_sel_hi:[1,0,1] neg_lo:[0,1,0]
    v_cvt_pk_bf16_f32 v209, v190, -v191
    v_pk_mul_f32 v[192:193], v[190:191], v[176:177] op_sel:[0,0] op_sel_hi:[0,1]
    v_pk_fma_f32 v[184:185], v[190:191], v[176:177], v[192:193] op_sel:[1,1,0] op_sel_hi:[1,0,1] neg_lo:[0,1,0]
    v_cvt_pk_bf16_f32 v210, v184, -v185
    v_pk_mul_f32 v[192:193], v[184:185], v[176:177] op_sel:[0,0] op_sel_hi:[0,1]
    v_pk_fma_f32 v[186:187], v[184:185], v[176:177], v[192:193] op_sel:[1,1,0] op_sel_hi:[1,0,1] neg_lo:[0,1,0]
    buffer_load_dwordx4 v25, s[48:51], s86 offen offset:1024 lds
    v_cvt_pk_bf16_f32 v211, v186, -v187
    v_pk_mul_f32 v[192:193], v[190:191], v[180:181] op_sel:[0,0] op_sel_hi:[0,1]
    v_pk_fma_f32 v[188:189], v[190:191], v[180:181], v[192:193] op_sel:[1,1,0] op_sel_hi:[1,0,1] neg_lo:[0,1,0]
    v_cvt_pk_bf16_f32 v212, v188, -v189
    v_pk_mul_f32 v[192:193], v[188:189], v[176:177] op_sel:[0,0] op_sel_hi:[0,1]
    v_pk_fma_f32 v[184:185], v[188:189], v[176:177], v[192:193] op_sel:[1,1,0] op_sel_hi:[1,0,1] neg_lo:[0,1,0]
    v_cvt_pk_bf16_f32 v213, v184, -v185
    v_pk_mul_f32 v[192:193], v[184:185], v[176:177] op_sel:[0,0] op_sel_hi:[0,1]
    v_pk_fma_f32 v[186:187], v[184:185], v[176:177], v[192:193] op_sel:[1,1,0] op_sel_hi:[1,0,1] neg_lo:[0,1,0]
    v_cvt_pk_bf16_f32 v214, v186, -v187
    buffer_load_dwordx4 v26, s[48:51], s86 offen offset:2048 lds
    v_pk_mul_f32 v[192:193], v[188:189], v[180:181] op_sel:[0,0] op_sel_hi:[0,1]
    v_pk_fma_f32 v[190:191], v[188:189], v[180:181], v[192:193] op_sel:[1,1,0] op_sel_hi:[1,0,1] neg_lo:[0,1,0]
    v_cvt_pk_bf16_f32 v215, v190, -v191
    v_pk_mul_f32 v[192:193], v[190:191], v[178:179] op_sel:[0,0] op_sel_hi:[0,1]
    v_pk_fma_f32 v[184:185], v[190:191], v[178:179], v[192:193] op_sel:[1,1,0] op_sel_hi:[1,0,1] neg_lo:[0,1,0]
    v_cvt_pk_bf16_f32 v216, v184, -v185
    v_pk_mul_f32 v[192:193], v[190:191], v[180:181] op_sel:[0,0] op_sel_hi:[0,1]
    v_pk_fma_f32 v[188:189], v[190:191], v[180:181], v[192:193] op_sel:[1,1,0] op_sel_hi:[1,0,1] neg_lo:[0,1,0]
    v_cvt_pk_bf16_f32 v217, v188, -v189
    v_pk_mul_f32 v[192:193], v[188:189], v[178:179] op_sel:[0,0] op_sel_hi:[0,1]
    buffer_load_dwordx4 v27, s[48:51], s86 offen offset:3072 lds
    v_pk_fma_f32 v[184:185], v[188:189], v[178:179], v[192:193] op_sel:[1,1,0] op_sel_hi:[1,0,1] neg_lo:[0,1,0]
    v_cvt_pk_bf16_f32 v218, v184, -v185
    v_pk_mul_f32 v[192:193], v[188:189], v[180:181] op_sel:[0,0] op_sel_hi:[0,1]
    v_pk_fma_f32 v[190:191], v[188:189], v[180:181], v[192:193] op_sel:[1,1,0] op_sel_hi:[1,0,1] neg_lo:[0,1,0]
    v_cvt_pk_bf16_f32 v219, v190, -v191
    v_pk_mul_f32 v[192:193], v[190:191], v[178:179] op_sel:[0,0] op_sel_hi:[0,1]
    v_pk_fma_f32 v[184:185], v[190:191], v[178:179], v[192:193] op_sel:[1,1,0] op_sel_hi:[1,0,1] neg_lo:[0,1,0]
    v_cvt_pk_bf16_f32 v220, v184, -v185
    v_pk_mul_f32 v[192:193], v[190:191], v[180:181] op_sel:[0,0] op_sel_hi:[0,1]
    v_pk_fma_f32 v[188:189], v[190:191], v[180:181], v[192:193] op_sel:[1,1,0] op_sel_hi:[1,0,1] neg_lo:[0,1,0]
    s_add_u32 m0, s73, 69632
    s_add_u32 s86, s70, 163840
    buffer_load_dwordx4 v24, s[48:51], s86 offen offset:0 lds
    v_cvt_pk_bf16_f32 v221, v188, -v189
    v_pk_mul_f32 v[192:193], v[188:189], v[178:179] op_sel:[0,0] op_sel_hi:[0,1]
    v_pk_fma_f32 v[184:185], v[188:189], v[178:179], v[192:193] op_sel:[1,1,0] op_sel_hi:[1,0,1] neg_lo:[0,1,0]
    v_cvt_pk_bf16_f32 v222, v184, -v185
    v_mov_b32 v188, 0
    v_mov_b32 v189, 0
    v_mov_b32 v190, 0
    v_mov_b32 v191, 0
    v_and_b32 v169, 0x1f0, v8
    v_add_u32 v169, s87, v169
    buffer_load_dwordx4 v25, s[48:51], s86 offen offset:1024 lds
    v_and_b32 v170, 60, v5
    v_add_u32 v170, s88, v170
    v_add_u32 v167, s18, v8
    v_xor_b32 v168, 0x2000, v167
    v_sub_u32 v160, s88, v8
    v_add_u32 v161, 1024, v160
    v_add_u32 v162, 2048, v160
    v_add_u32 v163, 3072, v160
    buffer_load_dwordx4 v26, s[48:51], s86 offen offset:2048 lds
    buffer_load_dwordx4 v27, s[48:51], s86 offen offset:3072 lds
    buffer_load_dword v15, v5, s[52:55], s89 offen sc1
    s_waitcnt vmcnt(9)
    ds_read_b64_tr_b16 a[0:1], v11 offset:0
    ds_read_b64_tr_b16 a[2:3], v11 offset:1024
    ds_read_b64_tr_b16 a[4:5], v12 offset:0
    ds_read_b64_tr_b16 a[6:7], v12 offset:1024
    ds_read_b64_tr_b16 a[8:9], v11 offset:2048
    ds_read_b64_tr_b16 a[10:11], v11 offset:3072
    ds_read_b64_tr_b16 a[12:13], v12 offset:2048
    ds_read_b64_tr_b16 a[14:15], v12 offset:3072
    ds_read_b64_tr_b16 a[16:17], v11 offset:4096
    ds_read_b64_tr_b16 a[18:19], v11 offset:5120
    ds_read_b64_tr_b16 a[20:21], v12 offset:4096
    ds_read_b64_tr_b16 a[22:23], v12 offset:5120
    ds_read_b64_tr_b16 a[24:25], v11 offset:6144
    ds_read_b64_tr_b16 a[26:27], v11 offset:7168
    ds_read_b64_tr_b16 a[28:29], v12 offset:6144
    ds_read_b64_tr_b16 a[30:31], v12 offset:7168
    ds_read_b64_tr_b16 a[32:33], v11 offset:32768
    ds_read_b64_tr_b16 a[34:35], v11 offset:33792
    ds_read_b64_tr_b16 a[36:37], v12 offset:32768
    ds_read_b64_tr_b16 a[38:39], v12 offset:33792
    ds_read_b64_tr_b16 a[40:41], v11 offset:34816
    ds_read_b64_tr_b16 a[42:43], v11 offset:35840
    ds_read_b64_tr_b16 a[44:45], v12 offset:34816
    ds_read_b64_tr_b16 a[46:47], v12 offset:35840
    ds_read_b64_tr_b16 a[48:49], v11 offset:36864
    ds_read_b64_tr_b16 a[50:51], v11 offset:37888
    ds_read_b64_tr_b16 a[52:53], v12 offset:36864
    ds_read_b64_tr_b16 a[54:55], v12 offset:37888
    ds_read_b64_tr_b16 a[56:57], v11 offset:38912
    ds_read_b64_tr_b16 a[58:59], v11 offset:39936
    ds_read_b64_tr_b16 a[60:61], v12 offset:38912
    ds_read_b64_tr_b16 a[62:63], v12 offset:39936
    s_cmp_lg_u32 s61, 0
    s_cbranch_scc1 L_f1ok1
    s_waitcnt vmcnt(0)
    s_mov_b32 s79, 0
L_pc3:
    v_cmp_ne_u32 vcc, s60, v15
    s_cbranch_vccz L_pd3
    s_add_u32 s79, s79, 1
    s_cmp_gt_u32 s79, 100000
    s_cbranch_scc1 L_pd3
    s_sleep 4
    buffer_load_dword v15, v5, s[52:55], s89 offen offset:0 sc1
    s_waitcnt vmcnt(0)
    s_branch L_pc3
L_pd3:
L_f1ok1:
    s_barrier
    s_add_u32 m0, s87, 512
    s_nop 0
    buffer_load_dwordx4 v8, s[52:55], s6 offen offset:0 sc1 lds
    buffer_load_dwordx4 v8, s[52:55], s6 offen offset:1024 sc1 lds
    buffer_load_dwordx4 v8, s[52:55], s6 offen offset:2048 sc1 lds
    buffer_load_dwordx4 v8, s[52:55], s6 offen offset:3072 sc1 lds
    ds_write2st64_b32 v194, v48, v232 offset0:0 offset1:16
    v_xor_b32 v195, 16, v194
    ds_write2st64_b32 v195, v49, v233 offset0:1 offset1:17
    v_xor_b32 v195, 32, v194
    ds_write2st64_b32 v195, v50, v234 offset0:2 offset1:18
    v_xor_b32 v195, 48, v194
    ds_write2st64_b32 v195, v51, v235 offset0:3 offset1:19
    v_xor_b32 v195, 64, v194
    ds_write2st64_b32 v195, v52, v236 offset0:4 offset1:20
    v_xor_b32 v195, 80, v194
    ds_write2st64_b32 v195, v53, v237 offset0:5 offset1:21
    v_xor_b32 v195, 96, v194
    ds_write2st64_b32 v195, v54, v238 offset0:6 offset1:22
    v_xor_b32 v195, 112, v194
    ds_write2st64_b32 v195, v55, v239 offset0:7 offset1:23
    v_xor_b32 v195, 128, v194
    ds_write2st64_b32 v195, v56, v240 offset0:8 offset1:24
    v_xor_b32 v195, 144, v194
    ds_write2st64_b32 v195, v57, v241 offset0:9 offset1:25
    v_xor_b32 v195, 160, v194
    ds_write2st64_b32 v195, v58, v242 offset0:10 offset1:26
    v_xor_b32 v195, 176, v194
    ds_write2st64_b32 v195, v59, v243 offset0:11 offset1:27
    v_xor_b32 v195, 192, v194
    ds_write2st64_b32 v195, v60, v244 offset0:12 offset1:28
    v_xor_b32 v195, 208, v194
    ds_write2st64_b32 v195, v61, v245 offset0:13 offset1:29
    v_xor_b32 v195, 224, v194
    ds_write2st64_b32 v195, v62, v246 offset0:14 offset1:30
    v_xor_b32 v195, 240, v194
    ds_write2st64_b32 v195, v63, v247 offset0:15 offset1:31
    ds_read_b128 a[192:195], v223
    ds_read_b128 a[196:199], v224
    ds_read_b128 a[200:203], v225
    ds_read_b128 a[204:207], v226
    ds_read_b128 a[208:211], v227
    ds_read_b128 a[212:215], v228
    ds_read_b128 a[216:219], v229
    ds_read_b128 a[220:223], v230
    ds_write2st64_b32 v194, v196, v209 offset0:0 offset1:16
    v_xor_b32 v195, 16, v194
    ds_write2st64_b32 v195, v197, v210 offset0:1 offset1:17
    v_xor_b32 v195, 32, v194
    ds_write2st64_b32 v195, v198, v211 offset0:2 offset1:18
    v_xor_b32 v195, 64, v194
    ds_write2st64_b32 v195, v204, v212 offset0:4 offset1:20
    v_xor_b32 v195, 80, v194
    ds_write2st64_b32 v195, v204, v213 offset0:5 offset1:21
    v_xor_b32 v195, 96, v194
    ds_write2st64_b32 v195, v205, v214 offset0:6 offset1:22
    v_xor_b32 v195, 48, v194
    ds_write2st64_b32 v195, v199, v215 offset0:3 offset1:19
    v_xor_b32 v195, 128, v194
    ds_write2st64_b32 v195, v200, v216 offset0:8 offset1:24
    v_xor_b32 v195, 112, v194
    ds_write2st64_b32 v195, v206, v217 offset0:7 offset1:23
    v_xor_b32 v195, 192, v194
    ds_write2st64_b32 v195, v206, v218 offset0:12 offset1:28
    v_xor_b32 v195, 144, v194
    ds_write2st64_b32 v195, v201, v219 offset0:9 offset1:25
    v_xor_b32 v195, 160, v194
    ds_write2st64_b32 v195, v202, v220 offset0:10 offset1:26
    v_xor_b32 v195, 176, v194
    ds_write2st64_b32 v195, v203, v220 offset0:11 offset1:27
    v_xor_b32 v195, 208, v194
    ds_write2st64_b32 v195, v206, v221 offset0:13 offset1:29
    v_xor_b32 v195, 224, v194
    ds_write2st64_b32 v195, v207, v222 offset0:14 offset1:30
    v_xor_b32 v195, 240, v194
    ds_write2st64_b32 v195, v208, v222 offset0:15 offset1:31
    ds_read_b128 a[224:227], v223
    ds_read_b128 a[228:231], v224
    ds_read_b128 a[232:235], v225
    ds_read_b128 a[236:239], v226
    ds_read_b128 a[240:243], v227
    ds_read_b128 a[244:247], v228
    ds_read_b128 a[248:251], v229
    ds_read_b128 a[252:255], v230
    s_waitcnt vmcnt(0)
L_common:
    s_waitcnt lgkmcnt(7)
    v_mfma_f32_32x32x16_bf16 v[48:63], a[224:227], a[192:195], 0
    s_waitcnt lgkmcnt(6)
    v_mfma_f32_32x32x16_bf16 v[48:63], a[228:231], a[196:199], v[48:63]
    s_waitcnt lgkmcnt(5)
    v_mfma_f32_32x32x16_bf16 v[48:63], a[232:235], a[200:203], v[48:63]
    s_waitcnt lgkmcnt(4)
    v_mfma_f32_32x32x16_bf16 v[48:63], a[236:239], a[204:207], v[48:63]
    s_waitcnt lgkmcnt(3)
    v_mfma_f32_32x32x16_bf16 v[48:63], a[240:243], a[208:211], v[48:63]
    s_waitcnt lgkmcnt(2)
    v_mfma_f32_32x32x16_bf16 v[48:63], a[244:247], a[212:215], v[48:63]
    s_waitcnt lgkmcnt(1)
    v_mfma_f32_32x32x16_bf16 v[48:63], a[248:251], a[216:219], v[48:63]
    ds_write_b128 v169, v[188:191]
    s_waitcnt lgkmcnt(1)
    v_mfma_f32_32x32x16_bf16 v[48:63], a[252:255], a[220:223], v[48:63]
    s_nop 11
    ds_write_b128 v167, v[48:51] offset:4096
    ds_write_b128 v167, v[52:55] offset:5120
    ds_write_b128 v167, v[56:59] offset:6144
    ds_write_b128 v167, v[60:63] offset:7168
    s_waitcnt lgkmcnt(0)
    s_barrier
    ds_read_b128 v[196:199], v168 offset:4096
    ds_read_b128 v[200:203], v168 offset:5120
    ds_read_b128 v[204:207], v168 offset:6144
    ds_read_b128 v[208:211], v168 offset:7168
    ds_write_b32 v170, v188 offset:3088
    s_add_u32 m0, s73, 0
    s_add_u32 s86, s70, 196608
    buffer_load_dwordx4 v24, s[48:51], s86 offen offset:0 lds
    buffer_load_dwordx4 v25, s[48:51], s86 offen offset:1024 lds
    s_cmp_eq_u32 s84, 1
    s_waitcnt lgkmcnt(4)
    v_pk_add_f32 v[48:49], v[48:49], v[196:197]
    v_pk_add_f32 v[50:51], v[50:51], v[198:199]
    s_waitcnt lgkmcnt(3)
    v_pk_add_f32 v[52:53], v[52:53], v[200:201]
    v_pk_add_f32 v[54:55], v[54:55], v[202:203]
    v_cvt_pk_bf16_f32 v172, v55, v54
    v_cvt_pk_bf16_f32 v173, v53, v52
    v_cvt_pk_bf16_f32 v174, v51, v50
    v_cvt_pk_bf16_f32 v175, v49, v48
    s_cbranch_scc1 L_kw0
    ds_write2_b32 v163, v172, v173 offset0:0 offset1:1
    ds_write2_b32 v163, v174, v175 offset0:2 offset1:3
    s_branch L_kx0
L_kw0:
    ds_write_b128 v163, v[172:175]
L_kx0:
    s_waitcnt lgkmcnt(3)
    v_pk_add_f32 v[56:57], v[56:57], v[204:205]
    v_pk_add_f32 v[58:59], v[58:59], v[206:207]
    s_waitcnt lgkmcnt(2)
    v_pk_add_f32 v[60:61], v[60:61], v[208:209]
    v_pk_add_f32 v[62:63], v[62:63], v[210:211]
    v_cvt_pk_bf16_f32 v176, v58, v58
    v_cvt_pk_bf16_f32 v177, v57, v57
    v_cvt_pk_bf16_f32 v178, v57, v56
    v_cvt_pk_bf16_f32 v179, v56, v56
    s_cbranch_scc1 L_kw1
    ds_write2_b32 v162, v176, v177 offset0:0 offset1:1
    ds_write2_b32 v162, v178, v179 offset0:2 offset1:3
    s_branch L_kx1
L_kw1:
    ds_write_b128 v162, v[176:179]
L_kx1:
    v_cndmask_b32 v63, v59, v60, s[92:93]
    v_cvt_pk_bf16_f32 v180, v60, v60
    v_cvt_pk_bf16_f32 v182, v59, v59
    v_cvt_pk_bf16_f32 v181, v60, v63
    s_cbranch_scc1 L_kw2
    ds_write2_b32 v161, v180, v181 offset0:0 offset1:1
    ds_write2_b32 v161, v182, v182 offset0:2 offset1:3
    s_branch L_kx2
L_kw2:
    v_mov_b32 v183, v182
    ds_write_b128 v161, v[180:183]
L_kx2:
    v_cndmask_b32 v63, v61, v62, s[92:93]
    v_cvt_pk_bf16_f32 v184, v62, v62
    v_cvt_pk_bf16_f32 v186, v61, v61
    v_cvt_pk_bf16_f32 v185, v62, v63
    s_cbranch_scc1 L_kw3
    ds_write2_b32 v160, v184, v185 offset0:0 offset1:1
    ds_write2_b32 v160, v186, v186 offset0:2 offset1:3
    s_branch L_kx3
L_kw3:
    v_mov_b32 v187, v186
    ds_write_b128 v160, v[184:187]
L_kx3:
    buffer_load_dwordx4 v26, s[48:51], s86 offen offset:2048 lds
    buffer_load_dwordx4 v27, s[48:51], s86 offen offset:3072 lds
    s_waitcnt vmcnt(4)
    v_mov_b32 v2, s60
    v_lshlrev_b32 v3, 9, v1
    s_mov_b64 exec, 1
    buffer_store_dword v2, v3, s[52:55], s8 offen sc1
    s_mov_b64 exec, -1
    s_waitcnt lgkmcnt(0)
    s_barrier
    ds_read_b128 v[160:163], v10 offset:192
    ds_read_b64 v[128:129], v9 offset:3776
    ds_read_b64 v[130:131], v9 offset:3784
    ds_read_b128 v[164:167], v10 offset:704
    ds_read_b64 v[132:133], v9 offset:3264
    ds_read_b64 v[134:135], v9 offset:3272
    ds_read_b128 v[168:171], v10 offset:1216
    ds_read_b64 v[136:137], v9 offset:2752
    ds_read_b64 v[138:139], v9 offset:2760
    ds_read_b128 v[172:175], v10 offset:1728
    ds_read_b64 v[140:141], v9 offset:2240
    ds_read_b64 v[142:143], v9 offset:2248
    ds_read_b128 v[176:179], v10 offset:2240
    ds_read_b64 v[144:145], v9 offset:1728
    ds_read_b64 v[146:147], v9 offset:1736
    ds_read_b128 v[180:183], v10 offset:2752
    ds_read_b64 v[148:149], v9 offset:1216
    ds_read_b64 v[150:151], v9 offset:1224
    ds_read_b128 v[184:187], v10 offset:3264
    ds_read_b64 v[152:153], v9 offset:704
    ds_read_b64 v[154:155], v9 offset:712
    ds_read_b128 v[188:191], v10 offset:3776
    ds_read_b64 v[156:157], v9 offset:192
    ds_read_b64 v[158:159], v9 offset:200
    s_waitcnt lgkmcnt(15)
    v_mfma_f32_16x16x32_bf16 a[224:227], v[128:131], v[160:163], 0
    ds_read_b64_tr_b16 a[64:65], v13 offset:0
    ds_read_b64_tr_b16 a[66:67], v13 offset:1024
    v_mfma_f32_16x16x32_bf16 a[228:231], v[128:131], v[164:167], 0
    s_add_u32 m0, s73, 4096
    s_add_u32 s86, s70, 229376
    buffer_load_dwordx4 v24, s[48:51], s86 offen offset:0 lds
    v_mfma_f32_16x16x32_bf16 a[228:231], v[132:135], v[160:163], a[228:231]
    ds_read_b64_tr_b16 a[68:69], v14 offset:0
    ds_read_b64_tr_b16 a[70:71], v14 offset:1024
    v_mfma_f32_16x16x32_bf16 a[232:235], v[132:135], v[164:167], 0
    ds_read_b64_tr_b16 a[72:73], v13 offset:2048
    ds_read_b64_tr_b16 a[74:75], v13 offset:3072
    v_mfma_f32_16x16x32_bf16 a[232:235], v[128:131], v[168:171], a[232:235]
    ds_read_b64_tr_b16 a[76:77], v14 offset:2048
    ds_read_b64_tr_b16 a[78:79], v14 offset:3072
    v_mfma_f32_16x16x32_bf16 a[232:235], v[136:139], v[160:163], a[232:235]
    ds_read_b64_tr_b16 a[80:81], v13 offset:4096
    ds_read_b64_tr_b16 a[82:83], v13 offset:5120
    v_mfma_f32_16x16x32_bf16 a[236:239], v[132:135], v[168:171], 0
    buffer_load_dwordx4 v25, s[48:51], s86 offen offset:1024 lds
    v_mfma_f32_16x16x32_bf16 a[236:239], v[136:139], v[164:167], a[236:239]
    ds_read_b64_tr_b16 a[84:85], v14 offset:4096
    ds_read_b64_tr_b16 a[86:87], v14 offset:5120
    v_mfma_f32_16x16x32_bf16 a[240:243], v[136:139], v[168:171], 0
    ds_read_b64_tr_b16 a[88:89], v13 offset:6144
    ds_read_b64_tr_b16 a[90:91], v13 offset:7168
    s_waitcnt lgkmcnt(15)
    v_mfma_f32_16x16x32_bf16 a[236:239], v[128:131], v[172:175], a[236:239]
    ds_read_b64_tr_b16 a[92:93], v14 offset:6144
    ds_read_b64_tr_b16 a[94:95], v14 offset:7168
    v_mfma_f32_16x16x32_bf16 a[236:239], v[140:143], v[160:163], a[236:239]
    ds_read_b128 v[96:99], v10 offset:128
    ds_read_b64 v[64:65], v9 offset:3712
    v_mfma_f32_16x16x32_bf16 a[240:243], v[132:135], v[172:175], a[240:243]
    buffer_load_dwordx4 v26, s[48:51], s86 offen offset:2048 lds
    v_mfma_f32_16x16x32_bf16 a[240:243], v[140:143], v[164:167], a[240:243]
    ds_read_b64 v[66:67], v9 offset:3720
    ds_read_b128 v[100:103], v10 offset:640
    v_mfma_f32_16x16x32_bf16 a[244:247], v[136:139], v[172:175], 0
    ds_read_b64 v[68:69], v9 offset:3200
    ds_read_b64 v[70:71], v9 offset:3208
    s_waitcnt lgkmcnt(6)
    v_mfma_f32_16x16x32_bf16 a[244:247], v[140:143], v[168:171], a[244:247]
    ds_read_b128 v[104:107], v10 offset:1152
    ds_read_b64 v[72:73], v9 offset:2688
    v_mfma_f32_16x16x32_bf16 a[248:251], v[140:143], v[172:175], 0
    ds_read_b64 v[74:75], v9 offset:2696
    ds_read_b128 v[108:111], v10 offset:1664
    v_mfma_f32_16x16x32_bf16 a[240:243], v[128:131], v[176:179], a[240:243]
    buffer_load_dwordx4 v27, s[48:51], s86 offen offset:3072 lds
    v_mfma_f32_16x16x32_bf16 a[240:243], v[144:147], v[160:163], a[240:243]
    ds_read_b64 v[76:77], v9 offset:2176
    ds_read_b64 v[78:79], v9 offset:2184
    v_mfma_f32_16x16x32_bf16 a[244:247], v[132:135], v[176:179], a[244:247]
    ds_read_b128 v[112:115], v10 offset:2176
    ds_read_b64 v[80:81], v9 offset:1664
    v_mfma_f32_16x16x32_bf16 a[244:247], v[144:147], v[164:167], a[244:247]
    ds_read_b64 v[82:83], v9 offset:1672
    ds_read_b128 v[116:119], v10 offset:2688
    v_mfma_f32_16x16x32_bf16 a[248:251], v[136:139], v[176:179], a[248:251]
    ds_read_b64 v[84:85], v9 offset:1152
    ds_read_b64 v[86:87], v9 offset:1160
    v_mfma_f32_16x16x32_bf16 a[248:251], v[144:147], v[168:171], a[248:251]
    s_add_u32 m0, s73, 32768
    s_add_u32 s86, s70, 262144
    buffer_load_dwordx4 v24, s[48:51], s86 offen offset:0 lds
    v_mfma_f32_16x16x32_bf16 a[252:255], v[140:143], v[176:179], 0
    ds_read_b128 v[120:123], v10 offset:3200
    ds_read_b64 v[88:89], v9 offset:640
    v_mfma_f32_16x16x32_bf16 a[252:255], v[144:147], v[172:175], a[252:255]
    ds_read_b64 v[90:91], v9 offset:648
    ds_read_b128 v[124:127], v10 offset:3712
    v_mfma_f32_16x16x32_bf16 a[244:247], v[128:131], v[180:183], a[244:247]
    ds_read_b64 v[92:93], v9 offset:128
    ds_read_b64 v[94:95], v9 offset:136
    v_mfma_f32_16x16x32_bf16 a[244:247], v[148:151], v[160:163], a[244:247]
    v_mfma_f32_16x16x32_bf16 a[248:251], v[132:135], v[180:183], a[248:251]
    buffer_load_dwordx4 v25, s[48:51], s86 offen offset:1024 lds
    v_mfma_f32_16x16x32_bf16 a[248:251], v[148:151], v[164:167], a[248:251]
    v_mfma_f32_16x16x32_bf16 a[252:255], v[136:139], v[180:183], a[252:255]
    v_mfma_f32_16x16x32_bf16 a[252:255], v[148:151], v[168:171], a[252:255]
    v_mfma_f32_16x16x32_bf16 a[248:251], v[128:131], v[184:187], a[248:251]
    v_mfma_f32_16x16x32_bf16 a[248:251], v[152:155], v[160:163], a[248:251]
    buffer_load_dwordx4 v26, s[48:51], s86 offen offset:2048 lds
    v_mfma_f32_16x16x32_bf16 a[252:255], v[132:135], v[184:187], a[252:255]
    v_mfma_f32_16x16x32_bf16 a[252:255], v[152:155], v[164:167], a[252:255]
    v_mfma_f32_16x16x32_bf16 a[252:255], v[128:131], v[188:191], a[252:255]
    v_mfma_f32_16x16x32_bf16 a[252:255], v[156:159], v[160:163], a[252:255]
    s_waitcnt lgkmcnt(12)
    v_mfma_f32_16x16x32_bf16 a[224:227], v[64:67], v[96:99], a[224:227]
    ds_read_b128 v[160:163], v10 offset:64
    ds_read_b64 v[128:129], v9 offset:3648
    v_mfma_f32_16x16x32_bf16 a[228:231], v[64:67], v[100:103], a[228:231]
    buffer_load_dwordx4 v27, s[48:51], s86 offen offset:3072 lds
    v_mfma_f32_16x16x32_bf16 a[228:231], v[68:71], v[96:99], a[228:231]
    ds_read_b64 v[130:131], v9 offset:3656
    ds_read_b128 v[164:167], v10 offset:576
    v_mfma_f32_16x16x32_bf16 a[232:235], v[68:71], v[100:103], a[232:235]
    ds_read_b64 v[132:133], v9 offset:3136
    ds_read_b64 v[134:135], v9 offset:3144
    v_mfma_f32_16x16x32_bf16 a[232:235], v[64:67], v[104:107], a[232:235]
    ds_read_b128 v[168:171], v10 offset:1088
    ds_read_b64 v[136:137], v9 offset:2624
    v_mfma_f32_16x16x32_bf16 a[232:235], v[72:75], v[96:99], a[232:235]
    ds_read_b64 v[138:139], v9 offset:2632
    ds_read_b128 v[172:175], v10 offset:1600
    v_mfma_f32_16x16x32_bf16 a[236:239], v[68:71], v[104:107], a[236:239]
    s_add_u32 m0, s73, 36864
    s_add_u32 s86, s70, 294912
    buffer_load_dwordx4 v24, s[48:51], s86 offen offset:0 lds
    v_mfma_f32_16x16x32_bf16 a[236:239], v[72:75], v[100:103], a[236:239]
    ds_read_b64 v[140:141], v9 offset:2112
    ds_read_b64 v[142:143], v9 offset:2120
    v_mfma_f32_16x16x32_bf16 a[240:243], v[72:75], v[104:107], a[240:243]
    ds_read_b128 v[176:179], v10 offset:2112
    ds_read_b64 v[144:145], v9 offset:1600
    v_mfma_f32_16x16x32_bf16 a[236:239], v[64:67], v[108:111], a[236:239]
    ds_read_b64 v[146:147], v9 offset:1608
    ds_read_b128 v[180:183], v10 offset:2624
    v_mfma_f32_16x16x32_bf16 a[236:239], v[76:79], v[96:99], a[236:239]
    ds_read_b64 v[148:149], v9 offset:1088
    ds_read_b64 v[150:151], v9 offset:1096
    v_mfma_f32_16x16x32_bf16 a[240:243], v[68:71], v[108:111], a[240:243]
    buffer_load_dwordx4 v25, s[48:51], s86 offen offset:1024 lds
    v_mfma_f32_16x16x32_bf16 a[240:243], v[76:79], v[100:103], a[240:243]
    ds_read_b128 v[184:187], v10 offset:3136
    ds_read_b64 v[152:153], v9 offset:576
    v_mfma_f32_16x16x32_bf16 a[244:247], v[72:75], v[108:111], a[244:247]
    ds_read_b64 v[154:155], v9 offset:584
    ds_read_b128 v[188:191], v10 offset:3648
    v_mfma_f32_16x16x32_bf16 a[244:247], v[76:79], v[104:107], a[244:247]
    ds_read_b64 v[156:157], v9 offset:64
    ds_read_b64 v[158:159], v9 offset:72
    v_mfma_f32_16x16x32_bf16 a[248:251], v[76:79], v[108:111], a[248:251]
    s_waitcnt lgkmcnt(15)
    v_mfma_f32_16x16x32_bf16 a[240:243], v[64:67], v[112:115], a[240:243]
    buffer_load_dwordx4 v26, s[48:51], s86 offen offset:2048 lds
    v_mfma_f32_16x16x32_bf16 a[240:243], v[80:83], v[96:99], a[240:243]
    v_mfma_f32_16x16x32_bf16 a[244:247], v[68:71], v[112:115], a[244:247]
    v_mfma_f32_16x16x32_bf16 a[244:247], v[80:83], v[100:103], a[244:247]
    v_mfma_f32_16x16x32_bf16 a[248:251], v[72:75], v[112:115], a[248:251]
    v_mfma_f32_16x16x32_bf16 a[248:251], v[80:83], v[104:107], a[248:251]
    buffer_load_dwordx4 v27, s[48:51], s86 offen offset:3072 lds
    v_mfma_f32_16x16x32_bf16 a[252:255], v[76:79], v[112:115], a[252:255]
    v_mfma_f32_16x16x32_bf16 a[252:255], v[80:83], v[108:111], a[252:255]
    v_mfma_f32_16x16x32_bf16 a[244:247], v[64:67], v[116:119], a[244:247]
    v_mfma_f32_16x16x32_bf16 a[244:247], v[84:87], v[96:99], a[244:247]
    v_mfma_f32_16x16x32_bf16 a[248:251], v[68:71], v[116:119], a[248:251]
    s_add_u32 m0, s73, 65536
    s_add_u32 s86, s70, 327680
    buffer_load_dwordx4 v24, s[48:51], s86 offen offset:0 lds
    v_mfma_f32_16x16x32_bf16 a[248:251], v[84:87], v[100:103], a[248:251]
    v_mfma_f32_16x16x32_bf16 a[252:255], v[72:75], v[116:119], a[252:255]
    v_mfma_f32_16x16x32_bf16 a[252:255], v[84:87], v[104:107], a[252:255]
    v_mfma_f32_16x16x32_bf16 a[248:251], v[64:67], v[120:123], a[248:251]
    v_mfma_f32_16x16x32_bf16 a[248:251], v[88:91], v[96:99], a[248:251]
    buffer_load_dwordx4 v25, s[48:51], s86 offen offset:1024 lds
    v_mfma_f32_16x16x32_bf16 a[252:255], v[68:71], v[120:123], a[252:255]
    v_mfma_f32_16x16x32_bf16 a[252:255], v[88:91], v[100:103], a[252:255]
    v_mfma_f32_16x16x32_bf16 a[252:255], v[64:67], v[124:127], a[252:255]
    v_mfma_f32_16x16x32_bf16 a[252:255], v[92:95], v[96:99], a[252:255]
    s_waitcnt vmcnt(10)
    s_waitcnt lgkmcnt(12)
    v_mfma_f32_16x16x32_bf16 a[224:227], v[128:131], v[160:163], a[224:227]
    ds_read_b64_tr_b16 a[96:97], v11 offset:0
    ds_read_b64_tr_b16 a[98:99], v11 offset:1024
    v_mfma_f32_16x16x32_bf16 a[228:231], v[128:131], v[164:167], a[228:231]
    buffer_load_dwordx4 v26, s[48:51], s86 offen offset:2048 lds
    v_mfma_f32_16x16x32_bf16 a[228:231], v[132:135], v[160:163], a[228:231]
    ds_read_b64_tr_b16 a[100:101], v12 offset:0
    ds_read_b64_tr_b16 a[102:103], v12 offset:1024
    v_mfma_f32_16x16x32_bf16 a[232:235], v[132:135], v[164:167], a[232:235]
    ds_read_b64_tr_b16 a[104:105], v11 offset:2048
    ds_read_b64_tr_b16 a[106:107], v11 offset:3072
    v_mfma_f32_16x16x32_bf16 a[232:235], v[128:131], v[168:171], a[232:235]
    ds_read_b64_tr_b16 a[108:109], v12 offset:2048
    ds_read_b64_tr_b16 a[110:111], v12 offset:3072
    v_mfma_f32_16x16x32_bf16 a[232:235], v[136:139], v[160:163], a[232:235]
    ds_read_b64_tr_b16 a[112:113], v11 offset:4096
    ds_read_b64_tr_b16 a[114:115], v11 offset:5120
    v_mfma_f32_16x16x32_bf16 a[236:239], v[132:135], v[168:171], a[236:239]
    buffer_load_dwordx4 v27, s[48:51], s86 offen offset:3072 lds
    v_mfma_f32_16x16x32_bf16 a[236:239], v[136:139], v[164:167], a[236:239]
    ds_read_b64_tr_b16 a[116:117], v12 offset:4096
    ds_read_b64_tr_b16 a[118:119], v12 offset:5120
    v_mfma_f32_16x16x32_bf16 a[240:243], v[136:139], v[168:171], a[240:243]
    ds_read_b64_tr_b16 a[120:121], v11 offset:6144
    ds_read_b64_tr_b16 a[122:123], v11 offset:7168
    v_mfma_f32_16x16x32_bf16 a[236:239], v[128:131], v[172:175], a[236:239]
    ds_read_b64_tr_b16 a[124:125], v12 offset:6144
    ds_read_b64_tr_b16 a[126:127], v12 offset:7168
    v_mfma_f32_16x16x32_bf16 a[236:239], v[140:143], v[160:163], a[236:239]
    ds_read_b128 v[96:99], v10 offset:0
    ds_read_b64 v[64:65], v9 offset:3584
    v_mfma_f32_16x16x32_bf16 a[240:243], v[132:135], v[172:175], a[240:243]
    s_add_u32 m0, s73, 69632
    s_add_u32 s86, s70, 360448
    buffer_load_dwordx4 v24, s[48:51], s86 offen offset:0 lds
    v_mfma_f32_16x16x32_bf16 a[240:243], v[140:143], v[164:167], a[240:243]
    ds_read_b64 v[66:67], v9 offset:3592
    ds_read_b128 v[100:103], v10 offset:512
    v_mfma_f32_16x16x32_bf16 a[244:247], v[136:139], v[172:175], a[244:247]
    ds_read_b64 v[68:69], v9 offset:3072
    ds_read_b64 v[70:71], v9 offset:3080
    s_waitcnt lgkmcnt(6)
    v_mfma_f32_16x16x32_bf16 a[244:247], v[140:143], v[168:171], a[244:247]
    ds_read_b128 v[104:107], v10 offset:1024
    ds_read_b64 v[72:73], v9 offset:2560
    v_mfma_f32_16x16x32_bf16 a[248:251], v[140:143], v[172:175], a[248:251]
    ds_read_b64 v[74:75], v9 offset:2568
    ds_read_b128 v[108:111], v10 offset:1536
    v_mfma_f32_16x16x32_bf16 a[240:243], v[128:131], v[176:179], a[240:243]
    buffer_load_dwordx4 v25, s[48:51], s86 offen offset:1024 lds
    v_mfma_f32_16x16x32_bf16 a[240:243], v[144:147], v[160:163], a[240:243]
    ds_read_b64 v[76:77], v9 offset:2048
    ds_read_b64 v[78:79], v9 offset:2056
    v_mfma_f32_16x16x32_bf16 a[244:247], v[132:135], v[176:179], a[244:247]
    ds_read_b128 v[112:115], v10 offset:2048
    ds_read_b64 v[80:81], v9 offset:1536
    v_mfma_f32_16x16x32_bf16 a[244:247], v[144:147], v[164:167], a[244:247]
    ds_read_b64 v[82:83], v9 offset:1544
    ds_read_b128 v[116:119], v10 offset:2560
    v_mfma_f32_16x16x32_bf16 a[248:251], v[136:139], v[176:179], a[248:251]
    ds_read_b64 v[84:85], v9 offset:1024
    ds_read_b64 v[86:87], v9 offset:1032
    v_mfma_f32_16x16x32_bf16 a[248:251], v[144:147], v[168:171], a[248:251]
    buffer_load_dwordx4 v26, s[48:51], s86 offen offset:2048 lds
    v_mfma_f32_16x16x32_bf16 a[252:255], v[140:143], v[176:179], a[252:255]
    ds_read_b128 v[120:123], v10 offset:3072
    ds_read_b64 v[88:89], v9 offset:512
    v_mfma_f32_16x16x32_bf16 a[252:255], v[144:147], v[172:175], a[252:255]
    ds_read_b64 v[90:91], v9 offset:520
    ds_read_b128 v[124:127], v10 offset:3584
    v_mfma_f32_16x16x32_bf16 a[244:247], v[128:131], v[180:183], a[244:247]
    ds_read_b64 v[92:93], v9 offset:0
    ds_read_b64 v[94:95], v9 offset:8
    v_mfma_f32_16x16x32_bf16 a[244:247], v[148:151], v[160:163], a[244:247]
    v_mfma_f32_16x16x32_bf16 a[248:251], v[132:135], v[180:183], a[248:251]
    buffer_load_dwordx4 v27, s[48:51], s86 offen offset:3072 lds
    v_mfma_f32_16x16x32_bf16 a[248:251], v[148:151], v[164:167], a[248:251]
    v_mfma_f32_16x16x32_bf16 a[252:255], v[136:139], v[180:183], a[252:255]
    v_mfma_f32_16x16x32_bf16 a[252:255], v[148:151], v[168:171], a[252:255]
    v_mfma_f32_16x16x32_bf16 a[248:251], v[128:131], v[184:187], a[248:251]
    v_mfma_f32_16x16x32_bf16 a[248:251], v[152:155], v[160:163], a[248:251]
    s_add_u32 m0, s73, 0
    s_add_u32 s86, s70, 393216
    buffer_load_dwordx4 v24, s[48:51], s86 offen offset:0 lds
    v_mfma_f32_16x16x32_bf16 a[252:255], v[132:135], v[184:187], a[252:255]
    v_mfma_f32_16x16x32_bf16 a[252:255], v[152:155], v[164:167], a[252:255]
    v_mfma_f32_16x16x32_bf16 a[252:255], v[128:131], v[188:191], a[252:255]
    v_mfma_f32_16x16x32_bf16 a[252:255], v[156:159], v[160:163], a[252:255]
    s_waitcnt lgkmcnt(12)
    v_mfma_f32_16x16x32_bf16 a[224:227], v[64:67], v[96:99], a[224:227]
    v_mfma_f32_16x16x32_bf16 a[228:231], v[64:67], v[100:103], a[228:231]
    buffer_load_dwordx4 v25, s[48:51], s86 offen offset:1024 lds
    v_mfma_f32_16x16x32_bf16 a[228:231], v[68:71], v[96:99], a[228:231]
    s_add_u32 s74, s73, 98304
    v_add_u32 v2, s74, v8
    v_mfma_f32_16x16x32_bf16 a[232:235], v[68:71], v[100:103], a[232:235]
    s_lshl_b32 s74, s61, 11
    s_add_u32 s74, s74, 98304
    v_mfma_f32_16x16x32_bf16 a[232:235], v[64:67], v[104:107], a[232:235]
    v_mfma_f32_16x16x32_bf16 a[232:235], v[72:75], v[96:99], a[232:235]
    v_and_b32 v3, 16, v8
    v_lshlrev_b32 v4, 1, v5
    v_mfma_f32_16x16x32_bf16 a[236:239], v[68:71], v[104:107], a[236:239]
    buffer_load_dwordx4 v26, s[48:51], s86 offen offset:2048 lds
    buffer_load_dword v46, v4, s[52:55], s16 offen sc1
    v_mfma_f32_16x16x32_bf16 a[236:239], v[72:75], v[100:103], a[236:239]
    v_mfma_f32_16x16x32_bf16 a[240:243], v[72:75], v[104:107], a[240:243]
    v_bfe_u32 v4, v1, 3, 3
    v_lshl_add_u32 v3, v4, 5, v3
    v_mfma_f32_16x16x32_bf16 a[236:239], v[64:67], v[108:111], a[236:239]
    v_bfe_u32 v4, v1, 1, 2
    v_lshl_add_u32 v3, v4, 8, v3
    v_mfma_f32_16x16x32_bf16 a[236:239], v[76:79], v[96:99], a[236:239]
    v_add_u32 v3, s74, v3
    v_mfma_f32_16x16x32_bf16 a[240:243], v[68:71], v[108:111], a[240:243]
    buffer_load_dwordx4 v27, s[48:51], s86 offen offset:3072 lds
    v_mfma_f32_16x16x32_bf16 a[240:243], v[76:79], v[100:103], a[240:243]
    v_mfma_f32_16x16x32_bf16 a[244:247], v[72:75], v[108:111], a[244:247]
    v_mfma_f32_16x16x32_bf16 a[244:247], v[76:79], v[104:107], a[244:247]
    v_mfma_f32_16x16x32_bf16 a[248:251], v[76:79], v[108:111], a[248:251]
    s_waitcnt lgkmcnt(0)
    s_barrier
    v_mfma_f32_16x16x32_bf16 a[240:243], v[64:67], v[112:115], a[240:243]
    s_add_u32 m0, s73, 4096
    s_add_u32 s86, s70, 425984
    buffer_load_dwordx4 v24, s[48:51], s86 offen offset:0 lds
    v_mfma_f32_16x16x32_bf16 a[240:243], v[80:83], v[96:99], a[240:243]
    v_mfma_f32_16x16x32_bf16 a[244:247], v[68:71], v[112:115], a[244:247]
    ds_write_b128 v2, a[224:227] offset:0
    v_mfma_f32_16x16x32_bf16 a[244:247], v[80:83], v[100:103], a[244:247]
    v_mfma_f32_16x16x32_bf16 a[248:251], v[72:75], v[112:115], a[248:251]
    v_mfma_f32_16x16x32_bf16 a[248:251], v[80:83], v[104:107], a[248:251]
    buffer_load_dwordx4 v25, s[48:51], s86 offen offset:1024 lds
    v_mfma_f32_16x16x32_bf16 a[252:255], v[76:79], v[112:115], a[252:255]
    ds_write_b128 v2, a[228:231] offset:1024
    v_mfma_f32_16x16x32_bf16 a[252:255], v[80:83], v[108:111], a[252:255]
    v_mfma_f32_16x16x32_bf16 a[244:247], v[64:67], v[116:119], a[244:247]
    v_mfma_f32_16x16x32_bf16 a[244:247], v[84:87], v[96:99], a[244:247]
    ds_write_b128 v2, a[232:235] offset:2048
    v_mfma_f32_16x16x32_bf16 a[248:251], v[68:71], v[116:119], a[248:251]
    buffer_load_dwordx4 v26, s[48:51], s86 offen offset:2048 lds
    v_mfma_f32_16x16x32_bf16 a[248:251], v[84:87], v[100:103], a[248:251]
    v_mfma_f32_16x16x32_bf16 a[252:255], v[72:75], v[116:119], a[252:255]
    ds_write_b128 v2, a[236:239] offset:3072
    v_mfma_f32_16x16x32_bf16 a[252:255], v[84:87], v[104:107], a[252:255]
    v_mfma_f32_16x16x32_bf16 a[248:251], v[64:67], v[120:123], a[248:251]
    buffer_load_dword v15, v6, s[52:55], s7 offen sc1
    ds_write_b128 v2, a[240:243] offset:4096
    v_mfma_f32_16x16x32_bf16 a[248:251], v[88:91], v[96:99], a[248:251]
    buffer_load_dwordx4 v27, s[48:51], s86 offen offset:3072 lds
    v_mfma_f32_16x16x32_bf16 a[252:255], v[68:71], v[120:123], a[252:255]
    v_mfma_f32_16x16x32_bf16 a[252:255], v[88:91], v[100:103], a[252:255]
    v_mfma_f32_16x16x32_bf16 a[252:255], v[64:67], v[124:127], a[252:255]
    ds_write_b128 v2, a[244:247] offset:5120
    v_mfma_f32_16x16x32_bf16 a[252:255], v[92:95], v[96:99], a[252:255]
    v_lshrrev_b32 v16, 2, v1
    v_and_b32 v17, 3, v1
    v_lshlrev_b32 v16, 10, v16
    v_lshl_add_u32 v16, v17, 4, v16
    s_add_u32 m0, s18, 4096
    v_add_u32 v17, 15360, v16
    ds_write_b128 v2, a[248:251] offset:6144
    s_nop 0
    ds_write_b128 v2, a[252:255] offset:7168
    buffer_load_dwordx4 v16, s[40:43], s83 offen offset:0 lds
    s_waitcnt lgkmcnt(0)
    s_barrier
    ds_read_b128 v[64:67], v3 offset:0
    ds_read_b128 v[68:71], v3 offset:8192
    ds_read_b128 v[72:75], v3 offset:16384
    ds_read_b128 v[76:79], v3 offset:24576
    ds_read_b128 v[80:83], v3 offset:1024
    ds_read_b128 v[84:87], v3 offset:9216
    ds_read_b128 v[88:91], v3 offset:17408
    ds_read_b128 v[92:95], v3 offset:25600
    buffer_load_dwordx4 v17, s[40:43], s83 offen offset:1024 lds
    s_waitcnt lgkmcnt(4)
    v_pk_add_f32 v[64:65], v[64:65], v[68:69]
    v_pk_add_f32 v[72:73], v[72:73], v[76:77]
    v_pk_add_f32 v[66:67], v[66:67], v[70:71]
    v_pk_add_f32 v[74:75], v[74:75], v[78:79]
    v_cvt_pk_bf16_f32 v36, v64, v72
    v_cvt_pk_bf16_f32 v37, v65, v73
    v_cvt_pk_bf16_f32 v38, v66, v74
    v_cvt_pk_bf16_f32 v39, v67, v75
    buffer_store_dwordx4 v[36:39], v7, s[52:55], s12 offen sc1
    s_waitcnt lgkmcnt(0)
    v_pk_add_f32 v[80:81], v[80:81], v[84:85]
    v_pk_add_f32 v[88:89], v[88:89], v[92:93]
    v_pk_add_f32 v[82:83], v[82:83], v[86:87]
    v_pk_add_f32 v[90:91], v[90:91], v[94:95]
    v_cvt_pk_bf16_f32 v40, v80, v88
    v_cvt_pk_bf16_f32 v41, v81, v89
    v_cvt_pk_bf16_f32 v42, v82, v90
    v_cvt_pk_bf16_f32 v43, v83, v91
    buffer_store_dwordx4 v[40:43], v7, s[52:55], s13 offen sc1
    s_waitcnt vmcnt(5)
    s_mov_b32 s79, 0
L_pc4:
    v_cmp_ne_u32 vcc, s60, v15
    s_cbranch_vccz L_pd4
    s_add_u32 s79, s79, 1
    s_cmp_gt_u32 s79, 100000
    s_cbranch_scc1 L_pd4
    s_sleep 4
    buffer_load_dword v15, v6, s[52:55], s7 offen offset:0 sc1
    s_waitcnt vmcnt(0)
    s_branch L_pc4
L_pd4:
    buffer_load_dwordx4 v[192:195], v8, s[52:55], s80 offen offset:0 sc1
    buffer_load_dwordx4 v[196:199], v8, s[52:55], s81 offen offset:0 sc1
    buffer_load_dwordx4 v[200:203], v8, s[52:55], s80 offen offset:1024 sc1
    buffer_load_dwordx4 v[204:207], v8, s[52:55], s81 offen offset:1024 sc1
    buffer_load_dwordx4 v[208:211], v8, s[52:55], s80 offen offset:2048 sc1
    buffer_load_dwordx4 v[212:215], v8, s[52:55], s81 offen offset:2048 sc1
    buffer_load_dwordx4 v[216:219], v8, s[52:55], s80 offen offset:3072 sc1
    buffer_load_dwordx4 v[220:223], v8, s[52:55], s81 offen offset:3072 sc1
    s_add_u32 s80, s80, 4096
    s_add_u32 s81, s81, 4096
    buffer_load_dwordx4 v[224:227], v8, s[52:55], s80 offen offset:0 sc1
    buffer_load_dwordx4 v[228:231], v8, s[52:55], s81 offen offset:0 sc1
    buffer_load_dwordx4 v[232:235], v8, s[52:55], s80 offen offset:1024 sc1
    buffer_load_dwordx4 v[236:239], v8, s[52:55], s81 offen offset:1024 sc1
    s_waitcnt vmcnt(10)
    v_mfma_f32_32x32x16_bf16 v[64:79], a[0:3], v[192:195], 0
    buffer_load_dwordx4 v[240:243], v8, s[52:55], s80 offen offset:2048 sc1
    ds_read_b64_tr_b16 a[128:129], v11 offset:32768
    ds_read_b64_tr_b16 a[130:131], v11 offset:33792
    v_mfma_f32_32x32x16_bf16 v[80:95], a[0:3], v[196:199], 0
    ds_read_b64_tr_b16 a[132:133], v12 offset:32768
    ds_read_b64_tr_b16 a[134:135], v12 offset:33792
    v_mfma_f32_32x32x16_bf16 v[96:111], a[4:7], v[192:195], 0
    buffer_load_dwordx4 v[244:247], v8, s[52:55], s81 offen offset:2048 sc1
    ds_read_b64_tr_b16 a[136:137], v11 offset:34816
    ds_read_b64_tr_b16 a[138:139], v11 offset:35840
    v_mfma_f32_32x32x16_bf16 v[112:127], a[4:7], v[196:199], 0
    ds_read_b64_tr_b16 a[140:141], v12 offset:34816
    ds_read_b64_tr_b16 a[142:143], v12 offset:35840
    s_waitcnt vmcnt(10)
    v_mfma_f32_32x32x16_bf16 v[64:79], a[8:11], v[200:203], v[64:79]
    buffer_load_dwordx4 v[248:251], v8, s[52:55], s80 offen offset:3072 sc1
    ds_read_b64_tr_b16 a[144:145], v11 offset:36864
    ds_read_b64_tr_b16 a[146:147], v11 offset:37888
    v_mfma_f32_32x32x16_bf16 v[80:95], a[8:11], v[204:207], v[80:95]
    ds_read_b64_tr_b16 a[148:149], v12 offset:36864
    ds_read_b64_tr_b16 a[150:151], v12 offset:37888
    v_mfma_f32_32x32x16_bf16 v[96:111], a[12:15], v[200:203], v[96:111]
    buffer_load_dwordx4 v[252:255], v8, s[52:55], s81 offen offset:3072 sc1
    ds_read_b64_tr_b16 a[152:153], v11 offset:38912
    ds_read_b64_tr_b16 a[154:155], v11 offset:39936
    v_mfma_f32_32x32x16_bf16 v[112:127], a[12:15], v[204:207], v[112:127]
    ds_read_b64_tr_b16 a[156:157], v12 offset:38912
    ds_read_b64_tr_b16 a[158:159], v12 offset:39936
    v_mov_b32 v2, s60
    v_lshlrev_b32 v3, 9, v1
    s_mov_b64 exec, 1
    buffer_store_dword v2, v3, s[52:55], s10 offen sc1
    s_mov_b64 exec, -1
    s_waitcnt vmcnt(11)
    v_mfma_f32_32x32x16_bf16 v[64:79], a[16:19], v[208:211], v[64:79]
    s_add_u32 s80, s80, 4096
    s_add_u32 s81, s81, 4096
    buffer_load_dwordx4 v[128:131], v8, s[52:55], s80 offen offset:0 sc1
    ds_read_b64_tr_b16 a[160:161], v13 offset:0
    ds_read_b64_tr_b16 a[162:163], v13 offset:1024
    v_mfma_f32_32x32x16_bf16 v[80:95], a[16:19], v[212:215], v[80:95]
    ds_read_b64_tr_b16 a[164:165], v14 offset:0
    ds_read_b64_tr_b16 a[166:167], v14 offset:1024
    v_mfma_f32_32x32x16_bf16 v[96:111], a[20:23], v[208:211], v[96:111]
    buffer_load_dwordx4 v[132:135], v8, s[52:55], s81 offen offset:0 sc1
    ds_read_b64_tr_b16 a[168:169], v13 offset:2048
    ds_read_b64_tr_b16 a[170:171], v13 offset:3072
    v_mfma_f32_32x32x16_bf16 v[112:127], a[20:23], v[212:215], v[112:127]
    ds_read_b64_tr_b16 a[172:173], v14 offset:2048
    ds_read_b64_tr_b16 a[174:175], v14 offset:3072
    s_waitcnt vmcnt(11)
    v_mfma_f32_32x32x16_bf16 v[64:79], a[24:27], v[216:219], v[64:79]
    buffer_load_dwordx4 v[136:139], v8, s[52:55], s80 offen offset:1024 sc1
    ds_read_b64_tr_b16 a[176:177], v13 offset:4096
    ds_read_b64_tr_b16 a[178:179], v13 offset:5120
    v_mfma_f32_32x32x16_bf16 v[80:95], a[24:27], v[220:223], v[80:95]
    ds_read_b64_tr_b16 a[180:181], v14 offset:4096
    ds_read_b64_tr_b16 a[182:183], v14 offset:5120
    v_mfma_f32_32x32x16_bf16 v[96:111], a[28:31], v[216:219], v[96:111]
    buffer_load_dwordx4 v[140:143], v8, s[52:55], s81 offen offset:1024 sc1
    ds_read_b64_tr_b16 a[184:185], v13 offset:6144
    ds_read_b64_tr_b16 a[186:187], v13 offset:7168
    v_mfma_f32_32x32x16_bf16 v[112:127], a[28:31], v[220:223], v[112:127]
    ds_read_b64_tr_b16 a[188:189], v14 offset:6144
    ds_read_b64_tr_b16 a[190:191], v14 offset:7168
    s_waitcnt vmcnt(11)
    v_mfma_f32_32x32x16_bf16 v[64:79], a[32:35], v[224:227], v[64:79]
    buffer_load_dwordx4 v[144:147], v8, s[52:55], s80 offen offset:2048 sc1
    ds_read_b64_tr_b16 a[192:193], v11 offset:0
    ds_read_b64_tr_b16 a[194:195], v11 offset:1024
    v_mfma_f32_32x32x16_bf16 v[80:95], a[32:35], v[228:231], v[80:95]
    ds_read_b64_tr_b16 a[196:197], v12 offset:0
    ds_read_b64_tr_b16 a[198:199], v12 offset:1024
    v_mfma_f32_32x32x16_bf16 v[96:111], a[36:39], v[224:227], v[96:111]
    buffer_load_dwordx4 v[148:151], v8, s[52:55], s81 offen offset:2048 sc1
    ds_read_b64_tr_b16 a[200:201], v11 offset:2048
    ds_read_b64_tr_b16 a[202:203], v11 offset:3072
    v_mfma_f32_32x32x16_bf16 v[112:127], a[36:39], v[228:231], v[112:127]
    ds_read_b64_tr_b16 a[204:205], v12 offset:2048
    ds_read_b64_tr_b16 a[206:207], v12 offset:3072
    s_waitcnt vmcnt(11)
    v_mfma_f32_32x32x16_bf16 v[64:79], a[40:43], v[232:235], v[64:79]
    buffer_load_dwordx4 v[152:155], v8, s[52:55], s80 offen offset:3072 sc1
    ds_read_b64_tr_b16 a[208:209], v11 offset:4096
    ds_read_b64_tr_b16 a[210:211], v11 offset:5120
    v_mfma_f32_32x32x16_bf16 v[80:95], a[40:43], v[236:239], v[80:95]
    ds_read_b64_tr_b16 a[212:213], v12 offset:4096
    ds_read_b64_tr_b16 a[214:215], v12 offset:5120
    v_mfma_f32_32x32x16_bf16 v[96:111], a[44:47], v[232:235], v[96:111]
    buffer_load_dwordx4 v[156:159], v8, s[52:55], s81 offen offset:3072 sc1
    ds_read_b64_tr_b16 a[216:217], v11 offset:6144
    ds_read_b64_tr_b16 a[218:219], v11 offset:7168
    v_mfma_f32_32x32x16_bf16 v[112:127], a[44:47], v[236:239], v[112:127]
    ds_read_b64_tr_b16 a[220:221], v12 offset:6144
    ds_read_b64_tr_b16 a[222:223], v12 offset:7168
    s_waitcnt vmcnt(11)
    v_mfma_f32_32x32x16_bf16 v[64:79], a[48:51], v[240:243], v[64:79]
    s_add_u32 s80, s80, 4096
    s_add_u32 s81, s81, 4096
    buffer_load_dwordx4 v[160:163], v8, s[52:55], s80 offen offset:0 sc1
    v_mfma_f32_32x32x16_bf16 v[80:95], a[48:51], v[244:247], v[80:95]
    v_mfma_f32_32x32x16_bf16 v[96:111], a[52:55], v[240:243], v[96:111]
    buffer_load_dwordx4 v[164:167], v8, s[52:55], s81 offen offset:0 sc1
    v_mfma_f32_32x32x16_bf16 v[112:127], a[52:55], v[244:247], v[112:127]
    s_waitcnt vmcnt(11)
    v_mfma_f32_32x32x16_bf16 v[64:79], a[56:59], v[248:251], v[64:79]
    buffer_load_dwordx4 v[168:171], v8, s[52:55], s80 offen offset:1024 sc1
    s_load_dwordx8 s[32:39], s[30:31], s19
    s_add_u32 s74, s19, 32
    s_load_dwordx4 s[44:47], s[30:31], s74
    v_mfma_f32_32x32x16_bf16 v[80:95], a[56:59], v[252:255], v[80:95]
    s_add_u32 s74, s19, 48
    s_load_dwordx4 s[64:67], s[30:31], s74
    v_and_b32 v18, 31, v1
    v_mfma_f32_32x32x16_bf16 v[96:111], a[60:63], v[248:251], v[96:111]
    buffer_load_dwordx4 v[172:175], v8, s[52:55], s81 offen offset:1024 sc1
    v_lshrrev_b32 v19, 5, v1
    v_lshlrev_b32 v10, 10, v18
    v_lshl_add_u32 v10, v19, 4, v10
    v_mfma_f32_32x32x16_bf16 v[112:127], a[60:63], v[252:255], v[112:127]
    v_lshrrev_b32 v9, 3, v18
    v_lshlrev_b32 v9, 5, v9
    v_and_b32 v4, 1, v18
    s_waitcnt vmcnt(10)
    v_mfma_f32_32x32x16_bf16 v[64:79], a[64:67], v[128:131], v[64:79]
    buffer_load_dwordx4 v[176:179], v8, s[52:55], s80 offen offset:2048 sc1
    v_lshl_add_u32 v9, v4, 4, v9
    v_bfe_u32 v4, v18, 1, 2
    v_lshl_add_u32 v9, v4, 2, v9
    v_mfma_f32_32x32x16_bf16 v[80:95], a[64:67], v[132:135], v[80:95]
    v_lshl_add_u32 v9, v19, 8, v9
    v_add_u32 v9, s18, v9
    v_and_b32 v24, 0x380, v8
    v_mfma_f32_32x32x16_bf16 v[96:111], a[68:71], v[128:131], v[96:111]
    buffer_load_dwordx4 v[180:183], v8, s[52:55], s81 offen offset:2048 sc1
    v_add_u32 v24, v24, v8
    v_add_u32 v25, 0x400, v24
    v_add_u32 v20, s73, v8
    v_mfma_f32_32x32x16_bf16 v[112:127], a[68:71], v[132:135], v[112:127]
    v_xor_b32 v21, 8192, v20
    v_xor_b32 v22, 16384, v20
    v_xor_b32 v23, 24576, v20
    s_waitcnt vmcnt(10)
    v_mfma_f32_32x32x16_bf16 v[64:79], a[72:75], v[136:139], v[64:79]
    buffer_load_dwordx4 v[184:187], v8, s[52:55], s80 offen offset:3072 sc1
    v_lshlrev_b32 v18, 6, v18
    v_lshl_add_u32 v18, v19, 3, v18
    v_add_u32 v18, s18, v18
    v_mfma_f32_32x32x16_bf16 v[80:95], a[72:75], v[140:143], v[80:95]
    ds_read_b64 v[36:37], v18 offset:4096
    ds_read_b64 v[38:39], v18 offset:4112
    ds_read_b64 v[40:41], v18 offset:4128
    v_mfma_f32_32x32x16_bf16 v[96:111], a[76:79], v[136:139], v[96:111]
    buffer_load_dwordx4 v[188:191], v8, s[52:55], s81 offen offset:3072 sc1
    ds_read_b64 v[42:43], v18 offset:4144
    v_and_b32 v16, s78, v46
    v_lshlrev_b32 v17, 16, v46
    v_mfma_f32_32x32x16_bf16 v[112:127], a[76:79], v[140:143], v[112:127]
    v_rcp_f32 v16, v16
    s_nop 0
    v_mul_f32 v17, v17, v16
    s_waitcnt vmcnt(10)
    v_mfma_f32_32x32x16_bf16 v[64:79], a[80:83], v[144:147], v[64:79]
    s_add_u32 s80, s80, 4096
    s_add_u32 s81, s81, 4096
    buffer_load_dwordx4 v[192:195], v8, s[52:55], s80 offen offset:0 sc1
    v_mul_f32 v47, v16, v16
    s_waitcnt lgkmcnt(0)
    v_mov_b32 v28, s32
    v_mfma_f32_32x32x16_bf16 v[80:95], a[80:83], v[148:151], v[80:95]
    v_mov_b32 v29, s33
    v_mov_b32 v30, s36
    v_mov_b32 v31, s37
    v_mfma_f32_32x32x16_bf16 v[96:111], a[84:87], v[144:147], v[96:111]
    buffer_load_dwordx4 v[196:199], v8, s[52:55], s81 offen offset:0 sc1
    v_mov_b32 v32, s44
    v_mov_b32 v33, s45
    v_mov_b32 v34, s64
    v_mfma_f32_32x32x16_bf16 v[112:127], a[84:87], v[148:151], v[112:127]
    v_mov_b32 v35, s65
    s_mov_b32 exec_lo, 0
    v_mov_b32 v28, s34
    v_mov_b32 v29, s35
    v_mov_b32 v30, s38
    v_mov_b32 v31, s39
    s_mov_b32 exec_lo, -1
    s_waitcnt vmcnt(10)
    v_mfma_f32_32x32x16_bf16 v[64:79], a[88:91], v[152:155], v[64:79]
    buffer_load_dwordx4 v[200:203], v8, s[52:55], s80 offen offset:1024 sc1
    s_mov_b32 exec_lo, 0
    v_mov_b32 v32, s46
    v_mov_b32 v33, s47
    v_mov_b32 v34, s66
    v_mov_b32 v35, s67
    s_mov_b32 exec_lo, -1
    v_mfma_f32_32x32x16_bf16 v[80:95], a[88:91], v[156:159], v[80:95]
    s_load_dwordx8 s[32:39], s[20:21], s19
    s_add_u32 s74, s19, 32
    s_load_dwordx4 s[44:47], s[20:21], s74
    v_mfma_f32_32x32x16_bf16 v[96:111], a[92:95], v[152:155], v[96:111]
    buffer_load_dwordx4 v[204:207], v8, s[52:55], s81 offen offset:1024 sc1
    s_add_u32 s74, s19, 48
    s_load_dwordx4 s[64:67], s[20:21], s74
    v_lshlrev_b32 v48, 16, v28
    v_mfma_f32_32x32x16_bf16 v[112:127], a[92:95], v[156:159], v[112:127]
    v_and_b32 v49, s78, v28
    v_lshlrev_b32 v50, 16, v29
    v_and_b32 v51, s78, v29
    s_waitcnt vmcnt(10)
    v_mfma_f32_32x32x16_bf16 v[64:79], a[96:99], v[160:163], v[64:79]
    buffer_load_dwordx4 v[208:211], v8, s[52:55], s80 offen offset:2048 sc1
    v_lshlrev_b32 v52, 16, v30
    v_and_b32 v53, s78, v30
    v_lshlrev_b32 v54, 16, v31
    v_mfma_f32_32x32x16_bf16 v[80:95], a[96:99], v[164:167], v[80:95]
    v_and_b32 v55, s78, v31
    v_lshlrev_b32 v56, 16, v32
    v_and_b32 v57, s78, v32
    v_mfma_f32_32x32x16_bf16 v[96:111], a[100:103], v[160:163], v[96:111]
    buffer_load_dwordx4 v[212:215], v8, s[52:55], s81 offen offset:2048 sc1
    v_lshlrev_b32 v58, 16, v33
    v_and_b32 v59, s78, v33
    v_lshlrev_b32 v60, 16, v34
    v_mfma_f32_32x32x16_bf16 v[112:127], a[100:103], v[164:167], v[112:127]
    v_and_b32 v61, s78, v34
    v_lshlrev_b32 v62, 16, v35
    v_and_b32 v63, s78, v35
    s_waitcnt vmcnt(10)
    v_mfma_f32_32x32x16_bf16 v[64:79], a[104:107], v[168:171], v[64:79]
    buffer_load_dwordx4 v[216:219], v8, s[52:55], s80 offen offset:3072 sc1
    s_waitcnt lgkmcnt(0)
    v_mov_b32 v28, s32
    v_mov_b32 v29, s33
    v_mfma_f32_32x32x16_bf16 v[80:95], a[104:107], v[172:175], v[80:95]
    v_mov_b32 v30, s36
    v_mov_b32 v31, s37
    v_mov_b32 v32, s44
    v_mfma_f32_32x32x16_bf16 v[96:111], a[108:111], v[168:171], v[96:111]
    buffer_load_dwordx4 v[220:223], v8, s[52:55], s81 offen offset:3072 sc1
    v_mov_b32 v33, s45
    v_mov_b32 v34, s64
    v_mov_b32 v35, s65
    v_mfma_f32_32x32x16_bf16 v[112:127], a[108:111], v[172:175], v[112:127]
    s_mov_b32 exec_lo, 0
    v_mov_b32 v28, s34
    v_mov_b32 v29, s35
    v_mov_b32 v30, s38
    v_mov_b32 v31, s39
    s_mov_b32 exec_lo, -1
    s_waitcnt vmcnt(10)
    v_mfma_f32_32x32x16_bf16 v[64:79], a[112:115], v[176:179], v[64:79]
    s_add_u32 s80, s80, 4096
    s_add_u32 s81, s81, 4096
    buffer_load_dwordx4 v[224:227], v8, s[52:55], s80 offen offset:0 sc1
    s_mov_b32 exec_lo, 0
    v_mov_b32 v32, s46
    v_mov_b32 v33, s47
    v_mov_b32 v34, s66
    v_mov_b32 v35, s67
    s_mov_b32 exec_lo, -1
    v_mfma_f32_32x32x16_bf16 v[80:95], a[112:115], v[180:183], v[80:95]
    v_lshlrev_b32 v4, 16, v36
    v_lshlrev_b32 v18, 16, v28
    v_fma_f32 v19, v4, v16, v17
    v_mfma_f32_32x32x16_bf16 v[96:111], a[116:119], v[176:179], v[96:111]
    buffer_load_dwordx4 v[228:231], v8, s[52:55], s81 offen offset:0 sc1
    v_add_f32 v48, v48, v4
    v_fmac_f32 v48, v19, v18
    v_and_b32 v4, s78, v36
    v_mfma_f32_32x32x16_bf16 v[112:127], a[116:119], v[180:183], v[112:127]
    v_and_b32 v18, s78, v28
    v_fma_f32 v19, v4, v16, v17
    v_add_f32 v49, v49, v4
    s_waitcnt vmcnt(10)
    v_mfma_f32_32x32x16_bf16 v[64:79], a[120:123], v[184:187], v[64:79]
    buffer_load_dwordx4 v[232:235], v8, s[52:55], s80 offen offset:1024 sc1
    v_fmac_f32 v49, v19, v18
    v_lshlrev_b32 v4, 16, v37
    v_lshlrev_b32 v18, 16, v29
    v_mfma_f32_32x32x16_bf16 v[80:95], a[120:123], v[188:191], v[80:95]
    v_fma_f32 v19, v4, v16, v17
    v_add_f32 v50, v50, v4
    v_fmac_f32 v50, v19, v18
    v_mfma_f32_32x32x16_bf16 v[96:111], a[124:127], v[184:187], v[96:111]
    buffer_load_dwordx4 v[236:239], v8, s[52:55], s81 offen offset:1024 sc1
    v_and_b32 v4, s78, v37
    v_and_b32 v18, s78, v29
    v_fma_f32 v19, v4, v16, v17
    v_mfma_f32_32x32x16_bf16 v[112:127], a[124:127], v[188:191], v[112:127]
    v_add_f32 v51, v51, v4
    v_fmac_f32 v51, v19, v18
    v_lshlrev_b32 v4, 16, v38
    s_waitcnt vmcnt(10)
    s_waitcnt lgkmcnt(0)
    v_mfma_f32_32x32x16_bf16 v[64:79], a[128:131], v[192:195], v[64:79]
    buffer_load_dwordx4 v[240:243], v8, s[52:55], s80 offen offset:2048 sc1
    v_lshlrev_b32 v18, 16, v30
    v_fma_f32 v19, v4, v16, v17
    v_add_f32 v52, v52, v4
    v_mfma_f32_32x32x16_bf16 v[80:95], a[128:131], v[196:199], v[80:95]
    v_fmac_f32 v52, v19, v18
    v_and_b32 v4, s78, v38
    v_and_b32 v18, s78, v30
    v_mfma_f32_32x32x16_bf16 v[96:111], a[132:135], v[192:195], v[96:111]
    buffer_load_dwordx4 v[244:247], v8, s[52:55], s81 offen offset:2048 sc1
    v_fma_f32 v19, v4, v16, v17
    v_add_f32 v53, v53, v4
    v_fmac_f32 v53, v19, v18
    v_mfma_f32_32x32x16_bf16 v[112:127], a[132:135], v[196:199], v[112:127]
    v_lshlrev_b32 v4, 16, v39
    v_lshlrev_b32 v18, 16, v31
    v_fma_f32 v19, v4, v16, v17
    s_waitcnt vmcnt(10)
    v_mfma_f32_32x32x16_bf16 v[64:79], a[136:139], v[200:203], v[64:79]
    buffer_load_dwordx4 v[248:251], v8, s[52:55], s80 offen offset:3072 sc1
    v_add_f32 v54, v54, v4
    v_fmac_f32 v54, v19, v18
    v_and_b32 v4, s78, v39
    v_mfma_f32_32x32x16_bf16 v[80:95], a[136:139], v[204:207], v[80:95]
    v_and_b32 v18, s78, v31
    v_fma_f32 v19, v4, v16, v17
    v_add_f32 v55, v55, v4
    v_mfma_f32_32x32x16_bf16 v[96:111], a[140:143], v[200:203], v[96:111]
    buffer_load_dwordx4 v[252:255], v8, s[52:55], s81 offen offset:3072 sc1
    v_fmac_f32 v55, v19, v18
    v_lshlrev_b32 v4, 16, v40
    v_lshlrev_b32 v18, 16, v32
    v_mfma_f32_32x32x16_bf16 v[112:127], a[140:143], v[204:207], v[112:127]
    v_fma_f32 v19, v4, v16, v17
    v_add_f32 v56, v56, v4
    v_fmac_f32 v56, v19, v18
    s_waitcnt vmcnt(10)
    v_mfma_f32_32x32x16_bf16 v[64:79], a[144:147], v[208:211], v[64:79]
    s_add_u32 s80, s80, 4096
    s_add_u32 s81, s81, 4096
    buffer_load_dwordx4 v[128:131], v8, s[52:55], s80 offen offset:0 sc1
    v_and_b32 v4, s78, v40
    v_and_b32 v18, s78, v32
    v_fma_f32 v19, v4, v16, v17
    v_mfma_f32_32x32x16_bf16 v[80:95], a[144:147], v[212:215], v[80:95]
    v_add_f32 v57, v57, v4
    v_fmac_f32 v57, v19, v18
    v_lshlrev_b32 v4, 16, v41
    v_mfma_f32_32x32x16_bf16 v[96:111], a[148:151], v[208:211], v[96:111]
    buffer_load_dwordx4 v[132:135], v8, s[52:55], s81 offen offset:0 sc1
    v_lshlrev_b32 v18, 16, v33
    v_fma_f32 v19, v4, v16, v17
    v_add_f32 v58, v58, v4
    v_mfma_f32_32x32x16_bf16 v[112:127], a[148:151], v[212:215], v[112:127]
    v_fmac_f32 v58, v19, v18
    v_and_b32 v4, s78, v41
    v_and_b32 v18, s78, v33
    v_and_b32 v44, 60, v5
    buffer_load_dword v45, v44, s[52:55], s11 offen sc1
    s_waitcnt vmcnt(11)
    v_mfma_f32_32x32x16_bf16 v[64:79], a[152:155], v[216:219], v[64:79]
    buffer_load_dwordx4 v[136:139], v8, s[52:55], s80 offen offset:1024 sc1
    v_fma_f32 v19, v4, v16, v17
    v_add_f32 v59, v59, v4
    v_fmac_f32 v59, v19, v18
    v_mfma_f32_32x32x16_bf16 v[80:95], a[152:155], v[220:223], v[80:95]
    v_lshlrev_b32 v4, 16, v42
    v_lshlrev_b32 v18, 16, v34
    v_fma_f32 v19, v4, v16, v17
    v_mfma_f32_32x32x16_bf16 v[96:111], a[156:159], v[216:219], v[96:111]
    buffer_load_dwordx4 v[140:143], v8, s[52:55], s81 offen offset:1024 sc1
    v_add_f32 v60, v60, v4
    v_fmac_f32 v60, v19, v18
    v_and_b32 v4, s78, v42
    v_mfma_f32_32x32x16_bf16 v[112:127], a[156:159], v[220:223], v[112:127]
    v_and_b32 v18, s78, v34
    v_fma_f32 v19, v4, v16, v17
    v_add_f32 v61, v61, v4
    s_waitcnt vmcnt(11)
    v_mfma_f32_32x32x16_bf16 v[64:79], a[160:163], v[224:227], v[64:79]
    buffer_load_dwordx4 v[144:147], v8, s[52:55], s80 offen offset:2048 sc1
    v_fmac_f32 v61, v19, v18
    v_lshlrev_b32 v4, 16, v43
    v_lshlrev_b32 v18, 16, v35
    v_mfma_f32_32x32x16_bf16 v[80:95], a[160:163], v[228:231], v[80:95]
    v_fma_f32 v19, v4, v16, v17
    v_add_f32 v62, v62, v4
    v_fmac_f32 v62, v19, v18
    v_mfma_f32_32x32x16_bf16 v[96:111], a[164:167], v[224:227], v[96:111]
    buffer_load_dwordx4 v[148:151], v8, s[52:55], s81 offen offset:2048 sc1
    v_and_b32 v4, s78, v43
    v_and_b32 v18, s78, v35
    v_fma_f32 v19, v4, v16, v17
    v_mfma_f32_32x32x16_bf16 v[112:127], a[164:167], v[228:231], v[112:127]
    v_add_f32 v63, v63, v4
    v_fmac_f32 v63, v19, v18
    s_waitcnt vmcnt(11)
    v_mfma_f32_32x32x16_bf16 v[64:79], a[168:171], v[232:235], v[64:79]
    buffer_load_dwordx4 v[152:155], v8, s[52:55], s80 offen offset:3072 sc1
    v_mfma_f32_32x32x16_bf16 v[80:95], a[168:171], v[236:239], v[80:95]
    v_mfma_f32_32x32x16_bf16 v[96:111], a[172:175], v[232:235], v[96:111]
    buffer_load_dwordx4 v[156:159], v8, s[52:55], s81 offen offset:3072 sc1
    v_mfma_f32_32x32x16_bf16 v[112:127], a[172:175], v[236:239], v[112:127]
    s_waitcnt vmcnt(11)
    v_mfma_f32_32x32x16_bf16 v[64:79], a[176:179], v[240:243], v[64:79]
    v_mfma_f32_32x32x16_bf16 v[80:95], a[176:179], v[244:247], v[80:95]
    v_mfma_f32_32x32x16_bf16 v[96:111], a[180:183], v[240:243], v[96:111]
    v_mfma_f32_32x32x16_bf16 v[112:127], a[180:183], v[244:247], v[112:127]
    s_waitcnt vmcnt(6)
    s_mov_b32 s79, 0
L_pc5:
    v_cmp_ne_u32 vcc, s60, v45
    s_cbranch_vccz L_pd5
    s_add_u32 s79, s79, 1
    s_cmp_gt_u32 s79, 100000
    s_cbranch_scc1 L_pd5
    s_sleep 4
    buffer_load_dword v45, v44, s[52:55], s11 offen offset:0 sc1
    s_waitcnt vmcnt(0)
    s_branch L_pc5
L_pd5:
    s_add_u32 m0, s18, 6144
    s_or_b32 s77, s2, s61
    s_lshl_b32 s77, s77, 24
    s_add_u32 s77, s77, 4096
    v_mfma_f32_32x32x16_bf16 v[64:79], a[184:187], v[248:251], v[64:79]
    buffer_load_dwordx4 v24, s[52:55], s9 offen offset:0 sc1 lds
    v_mfma_f32_32x32x16_bf16 v[80:95], a[184:187], v[252:255], v[80:95]
    buffer_load_dwordx4 v25, s[52:55], s9 offen offset:1024 sc1 lds
    v_mfma_f32_32x32x16_bf16 v[96:111], a[188:191], v[248:251], v[96:111]
    v_and_b32 v26, 0x3c0, v8
    v_add_u32 v26, v26, v8
    buffer_load_dwordx4 v[16:19], v26, s[52:55], s77 offen sc1
    v_mfma_f32_32x32x16_bf16 v[112:127], a[188:191], v[252:255], v[112:127]
    v_mfma_f32_32x32x16_bf16 v[64:79], a[192:195], v[128:131], v[64:79]
    v_mfma_f32_32x32x16_bf16 v[80:95], a[192:195], v[132:135], v[80:95]
    v_mfma_f32_32x32x16_bf16 v[96:111], a[196:199], v[128:131], v[96:111]
    v_mfma_f32_32x32x16_bf16 v[112:127], a[196:199], v[132:135], v[112:127]
    s_waitcnt vmcnt(3)
    v_mfma_f32_32x32x16_bf16 v[80:95], a[200:203], v[140:143], v[80:95]
    v_mfma_f32_32x32x16_bf16 v[80:95], a[208:211], v[148:151], v[80:95]
    v_mfma_f32_32x32x16_bf16 v[80:95], a[216:219], v[156:159], v[80:95]
    v_mfma_f32_32x32x16_bf16 v[96:111], a[204:207], v[136:139], v[96:111]
    v_mfma_f32_32x32x16_bf16 v[96:111], a[212:215], v[144:147], v[96:111]
    v_mfma_f32_32x32x16_bf16 v[96:111], a[220:223], v[152:155], v[96:111]
    s_nop 8
    ds_write_b128 v20, v[80:83] offset:0
    ds_write_b128 v20, v[84:87] offset:1024
    v_mfma_f32_32x32x16_bf16 v[112:127], a[204:207], v[140:143], v[112:127]
    ds_write_b128 v20, v[88:91] offset:2048
    ds_write_b128 v20, v[92:95] offset:3072
    v_mfma_f32_32x32x16_bf16 v[112:127], a[212:215], v[148:151], v[112:127]
    v_mfma_f32_32x32x16_bf16 v[112:127], a[220:223], v[156:159], v[112:127]
    ds_write_b128 v20, v[96:99] offset:4096
    ds_write_b128 v20, v[100:103] offset:5120
    v_mfma_f32_32x32x16_bf16 v[64:79], a[200:203], v[136:139], v[64:79]
    ds_write_b128 v20, v[104:107] offset:6144
    ds_write_b128 v20, v[108:111] offset:7168
    v_mfma_f32_32x32x16_bf16 v[64:79], a[208:211], v[144:147], v[64:79]
    v_mfma_f32_32x32x16_bf16 v[64:79], a[216:219], v[152:155], v[64:79]
    s_nop 4
    ds_write_b128 v20, v[112:115] offset:32768
    ds_write_b128 v20, v[116:119] offset:33792
    s_waitcnt vmcnt(1)
    ds_read_b32 v28, v9 offset:6144
    ds_read_b32 v29, v9 offset:6272
    ds_read_b32 v30, v9 offset:6656
    ds_read_b32 v31, v9 offset:6784
    ds_read_b32 v32, v9 offset:7168
    ds_read_b32 v33, v9 offset:7296
    ds_read_b32 v34, v9 offset:7680
    ds_read_b32 v35, v9 offset:7808
    ds_write_b128 v20, v[120:123] offset:34816
    ds_write_b128 v20, v[124:127] offset:35840
    s_waitcnt lgkmcnt(2)
    v_lshlrev_b32 v6, 16, v28
    v_add_f32 v48, v48, v6
    v_and_b32 v6, s78, v28
    v_add_f32 v49, v49, v6
    v_lshlrev_b32 v6, 16, v29
    v_add_f32 v50, v50, v6
    v_and_b32 v6, s78, v29
    v_add_f32 v51, v51, v6
    v_lshlrev_b32 v6, 16, v30
    v_add_f32 v52, v52, v6
    v_and_b32 v6, s78, v30
    v_add_f32 v53, v53, v6
    v_lshlrev_b32 v6, 16, v31
    v_add_f32 v54, v54, v6
    v_and_b32 v6, s78, v31
    v_add_f32 v55, v55, v6
    v_lshlrev_b32 v6, 16, v32
    v_add_f32 v56, v56, v6
    v_and_b32 v6, s78, v32
    v_add_f32 v57, v57, v6
    v_lshlrev_b32 v6, 16, v33
    v_add_f32 v58, v58, v6
    v_and_b32 v6, s78, v33
    v_add_f32 v59, v59, v6
    v_lshlrev_b32 v6, 16, v34
    v_add_f32 v60, v60, v6
    v_and_b32 v6, s78, v34
    v_add_f32 v61, v61, v6
    v_lshlrev_b32 v6, 16, v35
    v_add_f32 v62, v62, v6
    v_and_b32 v6, s78, v35
    v_add_f32 v63, v63, v6
    v_pk_fma_f32 v[48:49], v[64:65], v[46:47], v[48:49] op_sel:[0,1,0] op_sel_hi:[1,1,1]
    v_pk_fma_f32 v[50:51], v[66:67], v[46:47], v[50:51] op_sel:[0,1,0] op_sel_hi:[1,1,1]
    v_pk_fma_f32 v[52:53], v[68:69], v[46:47], v[52:53] op_sel:[0,1,0] op_sel_hi:[1,1,1]
    v_pk_fma_f32 v[54:55], v[70:71], v[46:47], v[54:55] op_sel:[0,1,0] op_sel_hi:[1,1,1]
    v_pk_fma_f32 v[56:57], v[72:73], v[46:47], v[56:57] op_sel:[0,1,0] op_sel_hi:[1,1,1]
    v_pk_fma_f32 v[58:59], v[74:75], v[46:47], v[58:59] op_sel:[0,1,0] op_sel_hi:[1,1,1]
    v_pk_fma_f32 v[60:61], v[76:77], v[46:47], v[60:61] op_sel:[0,1,0] op_sel_hi:[1,1,1]
    v_pk_fma_f32 v[62:63], v[78:79], v[46:47], v[62:63] op_sel:[0,1,0] op_sel_hi:[1,1,1]
    s_waitcnt lgkmcnt(0)
    s_barrier
    ds_read_b128 v[128:131], v21 offset:0
    ds_read_b128 v[132:135], v21 offset:1024
    ds_read_b128 v[144:147], v22 offset:4096
    ds_read_b128 v[148:151], v22 offset:5120
    ds_read_b128 v[160:163], v23 offset:32768
    ds_read_b128 v[164:167], v23 offset:33792
    ds_read_b128 v[136:139], v21 offset:2048
    ds_read_b128 v[140:143], v21 offset:3072
    ds_read_b128 v[152:155], v22 offset:6144
    ds_read_b128 v[156:159], v22 offset:7168
    ds_read_b128 v[168:171], v23 offset:34816
    ds_read_b128 v[172:175], v23 offset:35840
    s_waitcnt lgkmcnt(8)
    v_pk_add_f32 v[128:129], v[128:129], v[144:145]
    v_pk_add_f32 v[130:131], v[130:131], v[146:147]
    v_pk_add_f32 v[132:133], v[132:133], v[148:149]
    v_pk_add_f32 v[134:135], v[134:135], v[150:151]
    s_waitcnt lgkmcnt(6)
    v_pk_add_f32 v[128:129], v[128:129], v[160:161]
    v_pk_add_f32 v[130:131], v[130:131], v[162:163]
    v_pk_add_f32 v[132:133], v[132:133], v[164:165]
    v_pk_add_f32 v[134:135], v[134:135], v[166:167]
    v_pk_fma_f32 v[48:49], v[128:129], v[46:47], v[48:49] op_sel:[0,1,0] op_sel_hi:[1,1,1]
    v_pk_fma_f32 v[50:51], v[130:131], v[46:47], v[50:51] op_sel:[0,1,0] op_sel_hi:[1,1,1]
    v_pk_fma_f32 v[52:53], v[132:133], v[46:47], v[52:53] op_sel:[0,1,0] op_sel_hi:[1,1,1]
    v_pk_fma_f32 v[54:55], v[134:135], v[46:47], v[54:55] op_sel:[0,1,0] op_sel_hi:[1,1,1]
    v_cvt_pk_bf16_f32 v80, v48, v49
    v_cvt_pk_bf16_f32 v82, v52, v53
    v_cvt_pk_bf16_f32 v81, v50, v51
    v_cvt_pk_bf16_f32 v83, v54, v55
    v_permlane32_swap_b32 v80, v82
    s_nop 0
    v_permlane32_swap_b32 v81, v83
    buffer_store_dwordx4 v[80:83], v10, s[56:59], s83 offen offset:0
    s_waitcnt lgkmcnt(2)
    v_pk_add_f32 v[136:137], v[136:137], v[152:153]
    v_pk_add_f32 v[138:139], v[138:139], v[154:155]
    v_pk_add_f32 v[140:141], v[140:141], v[156:157]
    v_pk_add_f32 v[142:143], v[142:143], v[158:159]
    s_waitcnt lgkmcnt(0)
    v_pk_add_f32 v[136:137], v[136:137], v[168:169]
    v_pk_add_f32 v[138:139], v[138:139], v[170:171]
    v_pk_add_f32 v[140:141], v[140:141], v[172:173]
    v_pk_add_f32 v[142:143], v[142:143], v[174:175]
    v_pk_fma_f32 v[56:57], v[136:137], v[46:47], v[56:57] op_sel:[0,1,0] op_sel_hi:[1,1,1]
    v_pk_fma_f32 v[58:59], v[138:139], v[46:47], v[58:59] op_sel:[0,1,0] op_sel_hi:[1,1,1]
    v_pk_fma_f32 v[60:61], v[140:141], v[46:47], v[60:61] op_sel:[0,1,0] op_sel_hi:[1,1,1]
    v_pk_fma_f32 v[62:63], v[142:143], v[46:47], v[62:63] op_sel:[0,1,0] op_sel_hi:[1,1,1]
    v_cvt_pk_bf16_f32 v84, v56, v57
    v_cvt_pk_bf16_f32 v86, v60, v61
    v_cvt_pk_bf16_f32 v85, v58, v59
    v_cvt_pk_bf16_f32 v87, v62, v63
    v_permlane32_swap_b32 v84, v86
    s_nop 0
    v_permlane32_swap_b32 v85, v87
    buffer_store_dwordx4 v[84:87], v10, s[56:59], s83 offen offset:32
    s_or_b32 s74, s2, s61
    s_cmp_lg_u32 s74, 0
    s_cbranch_scc1 L_end
    s_waitcnt vmcnt(2)
    s_mov_b32 s79, 0
L_pc6:
    v_cmp_ne_u32 vcc, s60, v16
    v_cmp_ne_u32 s[90:91], s60, v17
    s_nop 0
    s_or_b64 vcc, vcc, s[90:91]
    v_cmp_ne_u32 s[90:91], s60, v18
    s_nop 0
    s_or_b64 vcc, vcc, s[90:91]
    v_cmp_ne_u32 s[90:91], s60, v19
    s_nop 0
    s_or_b64 vcc, vcc, s[90:91]
    s_cbranch_vccz L_pd6
    s_add_u32 s79, s79, 1
    s_cmp_gt_u32 s79, 100000
    s_cbranch_scc1 L_pd6
    s_sleep 4
    buffer_load_dwordx4 v[16:19], v26, s[52:55], s77 offen offset:0 sc1
    s_waitcnt vmcnt(0)
    s_branch L_pc6
L_pd6:
    s_mov_b32 s74, 0
    v_mov_b32 v2, s60
    v_lshlrev_b32 v3, 9, v1
    s_mov_b64 exec, 1
    buffer_store_dword v2, v3, s[52:55], s74 offen sc1
    s_mov_b64 exec, -1
L_end:
    s_endpgm
L_code_end:

.section .rodata,"a"
.p2align 6
.amdhsa_kernel parallel_sum__ssm_conv_s4__dense_activation_squared_relu__prompt_kernel
  .amdhsa_next_free_vgpr 512
  .amdhsa_next_free_sgpr 102
  .amdhsa_accum_offset 256
  .amdhsa_group_segment_fixed_size 0
  .amdhsa_kernarg_size 136
  .amdhsa_user_sgpr_count 2
  .amdhsa_user_sgpr_kernarg_segment_ptr 1
  .amdhsa_system_sgpr_workgroup_id_x 1
.end_amdhsa_kernel
```
